```python
import torch

def _softmax(x, axis=-1):
    return torch.softmax(x, dim=axis)
def _gelu(x):
    return torch.nn.functional.gelu(x, approximate="tanh")
def _silu(x):
    return torch.nn.functional.silu(x)
def _sigmoid(x):
    return torch.sigmoid(x)
def _layernorm(x, axis=-1, eps=1e-5):
    m = x.mean(dim=axis, keepdim=True)
    v = x.var(dim=axis, keepdim=True, unbiased=False)
    return (x - m) / torch.sqrt(v + eps)
def _scatter_add(tgt, idx, src, axis=0):
    return tgt.clone().index_add_(axis, idx, src)
def _segment_sum(src, seg, n):
    out = torch.zeros((n,) + src.shape[1:], dtype=src.dtype)
    return out.index_add_(0, seg, src)
def _pad(x, pw):
    flat = tuple(v for pair in reversed(pw) for v in pair)
    return torch.nn.functional.pad(x, flat)

kernel_name = 'sequential_preLN__ssm_conv_s4__mixer_s_mlp__prompt'

def setup_inputs():

    _w = (lambda a: (lambda t: t.to(torch.bfloat16) if t.is_floating_point() else t)(torch.as_tensor(a)))
    def _A_setup():
        B, L, D, N = 1, 2048, 576, 128
        A_re = -(lambda _x: torch.exp(torch.as_tensor(_x)))((lambda *s: torch.randn(*s, dtype=torch.bfloat16) * 3.2)(D, N))
        A_im = torch.pi * (lambda *s: torch.randn(*s, dtype=torch.bfloat16) * 0.05)(D, N)
        B_re = (lambda *s: torch.randn(*s, dtype=torch.bfloat16) * 0.1)(D, N)
        B_im = (lambda *s: torch.randn(*s, dtype=torch.bfloat16) * 0.1)(D, N)
        C_re = (lambda *s: torch.randn(*s, dtype=torch.bfloat16) * 0.1)(D, N)
        C_im = (lambda *s: torch.randn(*s, dtype=torch.bfloat16) * 0.1)(D, N)
        log_dt = (lambda *s: torch.randn(*s, dtype=torch.bfloat16) * 0.05)(D) * 0.5 - 4.0
        Dskip = (lambda *s: torch.randn(*s, dtype=torch.bfloat16) * 0.05)(D)
        return {
            "u": _w((lambda *s: torch.randn(*s, dtype=torch.bfloat16) * 0.05)(B, L, D)),
            "A_re": _w(A_re),
            "A_im": _w(A_im),
            "B_re": _w(B_re),
            "B_im": _w(B_im),
            "C_re": _w(C_re),
            "C_im": _w(C_im),
            "log_dt": _w(log_dt),
            "Dskip": _w(Dskip),
        }
    _A_in = _A_setup()

    def _B_setup():
        B, S, D, F = 1, 2048, 576, 4608
        return {
            "x":  _w((lambda *s: torch.randn(*s, dtype=torch.bfloat16) * 0.05)(B, S, D)),
            "w1": _w((lambda *s: torch.randn(*s, dtype=torch.bfloat16) * 3.2)(D, D) * (D ** -0.5)),
            "w2": _w((lambda *s: torch.randn(*s, dtype=torch.bfloat16) * 3.2)(D, D) * (D ** -0.5)),
            "w3": _w((lambda *s: torch.randn(*s, dtype=torch.bfloat16) * 3.2)(D, F) * (D ** -0.5)),
            "w4": _w((lambda *s: torch.randn(*s, dtype=torch.bfloat16) * 1.6)(F, D) * (F ** -0.5)),
        }
    _B_in = _B_setup()

    return {
        "A_u": _A_in["u"],
        "A_A_re": _A_in["A_re"],
        "A_A_im": _A_in["A_im"],
        "A_B_re": _A_in["B_re"],
        "A_B_im": _A_in["B_im"],
        "A_C_re": _A_in["C_re"],
        "A_C_im": _A_in["C_im"],
        "A_log_dt": _A_in["log_dt"],
        "A_Dskip": _A_in["Dskip"],
        "B_x": _B_in["x"],
        "B_w1": _B_in["w1"],
        "B_w2": _B_in["w2"],
        "B_w3": _B_in["w3"],
        "B_w4": _B_in["w4"],
    }

def reference(A_u, A_A_re, A_A_im, A_B_re, A_B_im, A_C_re, A_C_im, A_log_dt, A_Dskip, B_x, B_w1, B_w2, B_w3, B_w4):
    def _A_ref(u, A_re, A_im, B_re, B_im, C_re, C_im, log_dt, Dskip):
        Bsz, L, D = u.shape
        dt = torch.exp(log_dt)[:, None]
        A = A_re + 1j * A_im
        Bc = B_re + 1j * B_im
        Cc = C_re + 1j * C_im
        logdA = dt * A
        dB = dt * Bc
        l = (lambda x, dt: x.to(dt))(torch.arange(L), A_re.dtype)
        P = torch.exp(logdA[:, :, None] * l[None, None, :])
        K = torch.einsum("dn,dnl,dn->dl", Cc, P, dB).real
        L2 = 2 * L
        Kp = _pad(K, ((0, 0), (0, L)))
        up = (lambda x, *d: x.permute(*d))(u, 0, 2, 1)
        up = _pad(up, ((0, 0), (0, 0), (0, L)))
        Kf = (lambda x, axes=(-2,-1): torch.fft.rfft2(x.float(), dim=axes))(Kp[:, None, :], axes=(-2, -1))
        Uf = (lambda x, axes=(-2,-1): torch.fft.rfft2(x.float(), dim=axes))(up[:, :, None, :], axes=(-2, -1))
        Yf = Uf * Kf[None, :, :, :]
        y = (lambda x, s, axes=(-2,-1): torch.fft.irfft2(x, s=s, dim=axes).to(torch.bfloat16))(Yf, (1, L2), axes=(-2, -1))[:, :, 0, :L]
        y = (lambda x, *d: x.permute(*d))(y, 0, 2, 1) + u * Dskip[None, None, :]
        return y

    def _B_ref(x, w1, w2, w3, w4):
        B, S, D = x.shape
        h = _gelu(_layernorm(x, axis=-1) @ w1)
        c = D // 4
        g0 = _pad(h[:, :, 0*c:1*c], ((0, 0), (1, 0), (0, 0)))[:, :S, :]
        g1 = _pad(h[:, :, 1*c:2*c], ((0, 0), (0, 1), (0, 0)))[:, 1:, :]
        g2 = _pad(h[:, :, 2*c:3*c], ((0, 0), (2, 0), (0, 0)))[:, :S, :]
        g3 = _pad(h[:, :, 3*c:   ], ((0, 0), (0, 2), (0, 0)))[:, 2:, :]
        hs = torch.concatenate([g0, g1, g2, g3], axis=-1) @ w2
        x1 = x + hs
        h2 = _gelu(_layernorm(x1, axis=-1) @ w3) @ w4
        return x1 + h2

    x = A_u
    h = x + _A_ref(_layernorm(x, axis=-1), A_A_re, A_A_im, A_B_re, A_B_im, A_C_re, A_C_im, A_log_dt, A_Dskip)
    h2 = h + _B_ref(_layernorm(h, axis=-1), B_w1, B_w2, B_w3, B_w4)
    return h2
```

```asm
; @launch kernel=km_kernel grid=(256,1,1) block=(768,1,1) lds=163840
.amdgcn_target "amdgcn-amd-amdhsa--gfx950"
.text
.globl km_kernel
.p2align 8
.type km_kernel,@function
km_kernel:
    s_cmp_ge_u32 s2, 256
    s_cbranch_scc1 km_kernel_end
    s_load_dwordx2 s[4:5], s[0:1], 128
    s_load_dwordx2 s[6:7], s[0:1], 0
    s_load_dwordx2 s[60:61], s[0:1], 120
    s_getpc_b64 s[42:43]
km_kernel_pc0:
    s_bfe_u32 s16, s2, 0x20003
    s_lshl_b32 s16, s16, 13
    v_lshl_add_u32 v164, v0, 7, s16
    v_min_u32 v164, km_kernel_end-km_kernel_pc0, v164
    v_cmp_gt_u32 vcc, 64, v0
    s_and_saveexec_b64 s[40:41], vcc
    s_cbranch_execz cpf_1
    global_load_dword v163, v164, s[42:43]
cpf_1:
    s_mov_b64 exec, -1
    s_memrealtime s[44:45]
    v_lshrrev_b32 v2, 6, v0
    v_and_b32 v3, 63, v0
    v_readfirstlane_b32 s14, v2
    v_lshlrev_b32 v1, 4, v3
    s_and_b32 s12, s2, 7
    s_lshr_b32 s13, s2, 3
    s_mul_i32 s3, s12, 18
    s_add_u32 s3, s3, s13
    s_mov_b32 s15, 0
    s_or_b32 s16, s2, s14
    s_cmp_lg_u32 s16, 0
    s_waitcnt lgkmcnt(0)
    s_mov_b32 s62, 256
    s_mov_b32 s63, 0x20000
    s_cbranch_scc1 npub_2
    s_or_b32 s44, s44, 1
    v_mov_b32 v7, s44
    v_lshlrev_b32 v6, 2, v3
    buffer_store_dword v7, v6, s[60:63], 0 offen offset:128 sc1
npub_2:
    s_mov_b32 s20, s6
    s_and_b32 s21, s7, 0xffff
    s_mov_b32 s22, 0x240000
    s_mov_b32 s23, 0x20000
    s_cmp_lg_u32 s14, 0
    s_cbranch_scc1 nt_3
    v_mul_u32_u24 v165, 1152, v3
    s_mul_i32 s16, s13, 73728
    s_mul_i32 s17, s12, 144
    s_add_u32 s16, s16, s17
    buffer_load_dword v166, v165, s[20:23], s16 offen
    buffer_load_dword v167, v165, s[20:23], s16 offen offset:140
nt_3:
    s_mov_b32 s8, s4
    s_and_b32 s9, s5, 0xffff
    s_mov_b32 s10, 0x10000000
    s_mov_b32 s11, 0x20000
    s_movk_i32 s48, 128
    s_cmp_ge_u32 s13, 18
    s_cbranch_scc1 km_kernel_PW
    s_cmp_ge_u32 s14, 8
    s_cbranch_scc1 km_kernel_H
    s_load_dwordx16 s[24:39], s[0:1], 8
    s_and_b32 s20, s14, 3
    s_lshr_b32 s21, s14, 2
    s_lshl_b32 s22, s3, 2
    s_add_u32 s22, s22, s20
    s_lshl_b32 s23, s22, 8
    s_lshl_b32 s16, s21, 7
    s_add_u32 s23, s23, s16
    v_lshl_add_u32 v4, v3, 1, s23
    s_lshl_b32 s16, s22, 1
    v_mov_b32 v5, s16
    s_mul_i32 s18, s14, 15504
    v_lshl_add_u32 v6, v3, 2, s18
    s_waitcnt lgkmcnt(0)
    global_load_ushort v14, v5, s[36:37]
    global_load_ushort v8, v4, s[24:25]
    global_load_ushort v9, v4, s[26:27]
    global_load_ushort v10, v4, s[28:29]
    global_load_ushort v11, v4, s[30:31]
    global_load_ushort v12, v4, s[32:33]
    global_load_ushort v13, v4, s[34:35]
    global_load_ushort v15, v5, s[38:39]
    s_cmp_lg_u32 s14, 0
    s_cbranch_scc1 nz_4
    v_mov_b32 v28, 0
    v_lshlrev_b32 v29, 2, v3
    v_add_u32 v29, 163328, v29
    ds_write_b32 v29, v28
    s_waitcnt lgkmcnt(0)
nz_4:
    s_barrier
    v_and_b32 v7, 15, v3
    v_mul_u32_u24 v7, 272, v7
    v_lshrrev_b32 v2, 4, v3
    v_lshl_add_u32 v7, v2, 4, v7
    v_add_u32 v7, s18, v7
    v_mov_b32 v16, 0
    v_mov_b32 v17, 0
    v_mov_b32 v18, 0
    v_mov_b32 v19, 0
    v_mov_b32 v20, 0
    v_mov_b32 v21, 0
    v_mov_b32 v22, 0
    v_mov_b32 v23, 0
    v_mov_b32 v24, 0
    v_mov_b32 v25, 0
    v_mov_b32 v26, 0
    v_mov_b32 v27, 0
    s_cmp_eq_u32 s21, 0
    s_cbranch_scc1 pr_5
    s_setprio 1
pr_5:
    s_add_u32 s19, s20, 4
    s_mul_i32 s19, s19, 15504
    v_add_u32 v128, s19, v1
    s_lshl_b32 s41, s20, 2
    s_add_u32 s41, s41, 163344
    v_and_b32 v129, 15, v3
    v_lshl_add_u32 v129, v129, 4, s18
    v_and_b32 v130, 1, v2
    v_lshrrev_b32 v131, 1, v2
    v_lshl_add_u32 v132, v130, 3, v129
    v_lshl_add_u32 v132, v131, 8, v132
    v_lshl_add_u32 v133, v130, 8, v129
    v_mul_u32_u24 v134, 3584, v131
    v_add_u32 v133, v133, v134
    v_mul_u32_u24 v134, 1016, v131
    v_add_u32 v134, 8, v134
    v_mul_u32_u24 v134, v134, v130
    v_lshl_add_u32 v134, v131, 10, v134
    v_add_u32 v134, v134, v129
    v_lshlrev_b32 v129, 2, v3
    v_sub_u32 v136, 254, v129
    v_sub_u32 v137, 252, v129
    v_lshrrev_b32 v138, 1, v136
    v_and_b32 v138, 2, v138
    v_add3_u32 v138, v138, v136, 0
    v_and_b32 v138, 0xfffffffc, v138
    v_lshrrev_b32 v139, 1, v137
    v_and_b32 v139, 2, v139
    v_add3_u32 v139, v139, v137, 0
    v_and_b32 v139, 0xfffffffc, v139
    v_lshrrev_b32 v140, 2, v136
    v_and_b32 v140, 2, v140
    v_add3_u32 v140, v140, v136, 2
    v_and_b32 v140, 0xfffffff8, v140
    v_lshrrev_b32 v141, 2, v137
    v_and_b32 v141, 2, v141
    v_add3_u32 v141, v141, v137, 2
    v_and_b32 v141, 0xfffffff8, v141
    v_lshrrev_b32 v142, 3, v136
    v_and_b32 v142, 2, v142
    v_add3_u32 v142, v142, v136, 6
    v_and_b32 v142, 0xfffffff0, v142
    v_lshrrev_b32 v143, 3, v137
    v_and_b32 v143, 2, v143
    v_add3_u32 v143, v143, v137, 6
    v_and_b32 v143, 0xfffffff0, v143
    v_add_u32 v136, s18, v136
    v_add_u32 v137, s18, v137
    v_add_u32 v138, s18, v138
    v_add_u32 v139, s18, v139
    v_add_u32 v140, s18, v140
    v_add_u32 v141, s18, v141
    v_add_u32 v142, s18, v142
    v_add_u32 v143, s18, v143
    v_add_u32 v129, s19, v129
    v_mov_b32 v144, 0
    v_and_b32 v145, 15, v3
    v_lshrrev_b32 v146, 4, v3
    v_sub_u32 v147, 2047, v145
    v_lshrrev_b32 v147, 1, v147
    v_lshlrev_b32 v147, 2, v147
    v_lshl_add_u32 v147, v146, 4, v147
    v_and_b32 v156, 1, v145
    v_xor_b32 v156, 1, v156
    v_mul_u32_u24 v156, 4160, v156
    v_add3_u32 v147, v147, v156, s19
    v_add_u32 v150, -416, v147
    v_add_u32 v151, -1440, v147
    v_add_u32 v152, -2464, v147
    v_add_u32 v153, -3488, v147
    v_lshlrev_b32 v154, 5, v145
    v_lshl_add_u32 v156, v146, 3, v154
    v_lshl_add_u32 v154, v146, 4, v154
    s_mul_i32 s16, s20, 4608
    s_add_u32 s16, s16, 124544
    v_add_u32 v157, s16, v156
    s_sub_u32 s16, s16, 32
    v_add_u32 v154, s16, v154
    s_lshl_b32 s16, s20, 12
    s_add_u32 s16, s16, 142464
    v_add_u32 v156, s16, v156
    v_lshlrev_b32 v155, 5, v145
    v_and_b32 v148, 1, v146
    v_lshl_add_u32 v155, v148, 9, v155
    v_lshrrev_b32 v148, 1, v146
    v_lshl_add_u32 v155, v148, 4, v155
    s_waitcnt vmcnt(7)
    v_lshlrev_b32 v14, 16, v14
    v_mul_f32 v14, 0x3fb8aa3b, v14
    v_exp_f32 v14, v14
    s_nop 0
    v_cvt_pk_bf16_f32 v14, v14, v14
    v_and_b32 v14, 0xffff0000, v14
    s_waitcnt vmcnt(0)
    s_cmp_lg_u32 s14, 0
    s_cbranch_scc1 gg_6
    v_mov_b32 v158, 163368
    v_mov_b32 v159, 1
    s_mov_b64 exec, 1
    ds_add_u32 v158, v159
    s_mov_b64 exec, -1
gg_6:
    v_readfirstlane_b32 s40, v15
    v_lshlrev_b32 v28, 16, v8
    v_lshlrev_b32 v29, 16, v9
    v_lshlrev_b32 v30, 16, v10
    v_lshlrev_b32 v31, 16, v11
    v_lshlrev_b32 v32, 16, v12
    v_lshlrev_b32 v33, 16, v13
    v_mul_f32 v28, v14, v28
    v_mul_f32 v29, v14, v29
    v_mul_f32 v30, v14, v30
    v_mul_f32 v31, v14, v31
    v_mul_f32 v28, 0x3fb8aa3b, v28
    v_mul_f32 v29, 0x3e22f983, v29
    v_mul_f32 v46, 0x3f800000, v28
    v_mul_f32 v47, 0x3f800000, v29
    v_mul_f32 v48, 0x41000000, v28
    v_mul_f32 v49, 0x41000000, v29
    v_mul_f32 v50, 0x43000000, v28
    v_mul_f32 v51, 0x43000000, v29
    v_mul_f32 v52, 0x44800000, v28
    v_mul_f32 v53, 0x44800000, v29
    v_fract_f32 v47, v47
    v_fract_f32 v49, v49
    v_fract_f32 v51, v51
    v_fract_f32 v53, v53
    v_exp_f32 v46, v46
    v_exp_f32 v48, v48
    v_exp_f32 v50, v50
    v_exp_f32 v52, v52
    v_cos_f32 v34, v47
    v_sin_f32 v35, v47
    v_cos_f32 v36, v49
    v_sin_f32 v37, v49
    v_cos_f32 v38, v51
    v_sin_f32 v39, v51
    v_cos_f32 v40, v53
    v_sin_f32 v41, v53
    s_nop 0
    v_pk_mul_f32 v[34:35], v[34:35], v[46:47] op_sel_hi:[1,0]
    v_pk_mul_f32 v[36:37], v[36:37], v[48:49] op_sel_hi:[1,0]
    v_pk_mul_f32 v[38:39], v[38:39], v[50:51] op_sel_hi:[1,0]
    v_pk_mul_f32 v[40:41], v[40:41], v[52:53] op_sel_hi:[1,0]
    v_pk_mul_f32 v[46:47], v[32:33], v[30:31] op_sel:[1,1] op_sel_hi:[1,0]
    v_pk_fma_f32 v[60:61], v[32:33], v[30:31], v[46:47] op_sel:[0,0,0] op_sel_hi:[0,1,1] neg_lo:[0,0,1]
    v_pk_mul_f32 v[48:49], v[38:39], v[38:39] op_sel:[1,1] op_sel_hi:[1,0]
    v_pk_fma_f32 v[42:43], v[38:39], v[38:39], v[48:49] op_sel:[0,0,0] op_sel_hi:[0,1,1] neg_lo:[0,0,1]
    v_pk_mul_f32 v[50:51], v[42:43], v[42:43] op_sel:[1,1] op_sel_hi:[1,0]
    v_pk_fma_f32 v[44:45], v[42:43], v[42:43], v[50:51] op_sel:[0,0,0] op_sel_hi:[0,1,1] neg_lo:[0,0,1]
    v_cvt_pk_bf16_f32 v54, v60, -v61
    ds_write_b32 v6, v54 offset:0
    v_mov_b32 v57, 0x3f80
    ds_write_b32 v6, v57 offset:11152
    v_cvt_pk_bf16_f32 v55, v36, v37
    ds_write_b32 v6, v55 offset:11424
    v_pk_mul_f32 v[46:47], v[60:61], v[34:35] op_sel:[1,1] op_sel_hi:[1,0]
    v_pk_fma_f32 v[70:71], v[60:61], v[34:35], v[46:47] op_sel:[0,0,0] op_sel_hi:[0,1,1] neg_lo:[0,0,1]
    v_pk_mul_f32 v[50:51], v[36:37], v[36:37] op_sel:[1,1] op_sel_hi:[1,0]
    v_pk_fma_f32 v[62:63], v[36:37], v[36:37], v[50:51] op_sel:[0,0,0] op_sel_hi:[0,1,1] neg_lo:[0,0,1]
    v_cvt_pk_bf16_f32 v56, v62, v63
    ds_write_b32 v6, v56 offset:11696
    v_cvt_pk_bf16_f32 v57, v70, -v71
    ds_write_b32 v6, v57 offset:272
    v_pk_mul_f32 v[48:49], v[70:71], v[34:35] op_sel:[1,1] op_sel_hi:[1,0]
    v_pk_fma_f32 v[72:73], v[70:71], v[34:35], v[48:49] op_sel:[0,0,0] op_sel_hi:[0,1,1] neg_lo:[0,0,1]
    v_pk_mul_f32 v[52:53], v[62:63], v[36:37] op_sel:[1,1] op_sel_hi:[1,0]
    v_pk_fma_f32 v[64:65], v[62:63], v[36:37], v[52:53] op_sel:[0,0,0] op_sel_hi:[0,1,1] neg_lo:[0,0,1]
    v_cvt_pk_bf16_f32 v54, v64, v65
    ds_write_b32 v6, v54 offset:11968
    v_cvt_pk_bf16_f32 v55, v72, -v73
    ds_write_b32 v6, v55 offset:544
    v_pk_mul_f32 v[46:47], v[72:73], v[34:35] op_sel:[1,1] op_sel_hi:[1,0]
    v_pk_fma_f32 v[74:75], v[72:73], v[34:35], v[46:47] op_sel:[0,0,0] op_sel_hi:[0,1,1] neg_lo:[0,0,1]
    v_pk_mul_f32 v[50:51], v[64:65], v[36:37] op_sel:[1,1] op_sel_hi:[1,0]
    v_pk_fma_f32 v[62:63], v[64:65], v[36:37], v[50:51] op_sel:[0,0,0] op_sel_hi:[0,1,1] neg_lo:[0,0,1]
    v_cvt_pk_bf16_f32 v56, v62, v63
    ds_write_b32 v6, v56 offset:12240
    v_cvt_pk_bf16_f32 v57, v74, -v75
    ds_write_b32 v6, v57 offset:816
    v_pk_mul_f32 v[48:49], v[74:75], v[34:35] op_sel:[1,1] op_sel_hi:[1,0]
    v_pk_fma_f32 v[76:77], v[74:75], v[34:35], v[48:49] op_sel:[0,0,0] op_sel_hi:[0,1,1] neg_lo:[0,0,1]
    v_pk_mul_f32 v[52:53], v[62:63], v[36:37] op_sel:[1,1] op_sel_hi:[1,0]
    v_pk_fma_f32 v[64:65], v[62:63], v[36:37], v[52:53] op_sel:[0,0,0] op_sel_hi:[0,1,1] neg_lo:[0,0,1]
    v_cvt_pk_bf16_f32 v54, v64, v65
    ds_write_b32 v6, v54 offset:12512
    v_cvt_pk_bf16_f32 v55, v76, -v77
    ds_write_b32 v6, v55 offset:1088
    v_pk_mul_f32 v[46:47], v[76:77], v[34:35] op_sel:[1,1] op_sel_hi:[1,0]
    v_pk_fma_f32 v[78:79], v[76:77], v[34:35], v[46:47] op_sel:[0,0,0] op_sel_hi:[0,1,1] neg_lo:[0,0,1]
    v_pk_mul_f32 v[50:51], v[64:65], v[36:37] op_sel:[1,1] op_sel_hi:[1,0]
    v_pk_fma_f32 v[62:63], v[64:65], v[36:37], v[50:51] op_sel:[0,0,0] op_sel_hi:[0,1,1] neg_lo:[0,0,1]
    v_cvt_pk_bf16_f32 v56, v62, v63
    ds_write_b32 v6, v56 offset:12784
    v_cvt_pk_bf16_f32 v57, v78, -v79
    ds_write_b32 v6, v57 offset:1360
    v_pk_mul_f32 v[48:49], v[78:79], v[34:35] op_sel:[1,1] op_sel_hi:[1,0]
    v_pk_fma_f32 v[80:81], v[78:79], v[34:35], v[48:49] op_sel:[0,0,0] op_sel_hi:[0,1,1] neg_lo:[0,0,1]
    v_pk_mul_f32 v[52:53], v[62:63], v[36:37] op_sel:[1,1] op_sel_hi:[1,0]
    v_pk_fma_f32 v[64:65], v[62:63], v[36:37], v[52:53] op_sel:[0,0,0] op_sel_hi:[0,1,1] neg_lo:[0,0,1]
    v_cvt_pk_bf16_f32 v54, v64, v65
    ds_write_b32 v6, v54 offset:13056
    v_cvt_pk_bf16_f32 v55, v80, -v81
    ds_write_b32 v6, v55 offset:1632
    v_pk_mul_f32 v[46:47], v[80:81], v[34:35] op_sel:[1,1] op_sel_hi:[1,0]
    v_pk_fma_f32 v[82:83], v[80:81], v[34:35], v[46:47] op_sel:[0,0,0] op_sel_hi:[0,1,1] neg_lo:[0,0,1]
    v_pk_mul_f32 v[50:51], v[64:65], v[36:37] op_sel:[1,1] op_sel_hi:[1,0]
    v_pk_fma_f32 v[62:63], v[64:65], v[36:37], v[50:51] op_sel:[0,0,0] op_sel_hi:[0,1,1] neg_lo:[0,0,1]
    v_cvt_pk_bf16_f32 v56, v62, v63
    ds_write_b32 v6, v56 offset:13328
    v_cvt_pk_bf16_f32 v57, v82, -v83
    ds_write_b32 v6, v57 offset:1904
    v_pk_mul_f32 v[48:49], v[60:61], v[38:39] op_sel:[1,1] op_sel_hi:[1,0]
    v_pk_fma_f32 v[84:85], v[60:61], v[38:39], v[48:49] op_sel:[0,0,0] op_sel_hi:[0,1,1] neg_lo:[0,0,1]
    v_pk_mul_f32 v[52:53], v[62:63], v[36:37] op_sel:[1,1] op_sel_hi:[1,0]
    v_pk_fma_f32 v[64:65], v[62:63], v[36:37], v[52:53] op_sel:[0,0,0] op_sel_hi:[0,1,1] neg_lo:[0,0,1]
    v_cvt_pk_bf16_f32 v54, v64, v65
    ds_write_b32 v6, v54 offset:13600
    v_cvt_pk_bf16_f32 v55, v84, -v85
    ds_write_b32 v6, v55 offset:2176
    v_pk_mul_f32 v[46:47], v[70:71], v[38:39] op_sel:[1,1] op_sel_hi:[1,0]
    v_pk_fma_f32 v[66:67], v[70:71], v[38:39], v[46:47] op_sel:[0,0,0] op_sel_hi:[0,1,1] neg_lo:[0,0,1]
    v_pk_mul_f32 v[50:51], v[64:65], v[36:37] op_sel:[1,1] op_sel_hi:[1,0]
    v_pk_fma_f32 v[62:63], v[64:65], v[36:37], v[50:51] op_sel:[0,0,0] op_sel_hi:[0,1,1] neg_lo:[0,0,1]
    v_cvt_pk_bf16_f32 v56, v62, v63
    ds_write_b32 v6, v56 offset:13872
    v_cvt_pk_bf16_f32 v57, v66, -v67
    ds_write_b32 v6, v57 offset:2448
    v_pk_mul_f32 v[48:49], v[72:73], v[38:39] op_sel:[1,1] op_sel_hi:[1,0]
    v_pk_fma_f32 v[86:87], v[72:73], v[38:39], v[48:49] op_sel:[0,0,0] op_sel_hi:[0,1,1] neg_lo:[0,0,1]
    v_cvt_pk_bf16_f32 v54, v86, -v87
    ds_write_b32 v6, v54 offset:2720
    v_pk_mul_f32 v[46:47], v[74:75], v[38:39] op_sel:[1,1] op_sel_hi:[1,0]
    v_pk_fma_f32 v[66:67], v[74:75], v[38:39], v[46:47] op_sel:[0,0,0] op_sel_hi:[0,1,1] neg_lo:[0,0,1]
    v_pk_mul_f32 v[50:51], v[62:63], v[36:37] op_sel:[1,1] op_sel_hi:[1,0]
    v_pk_fma_f32 v[64:65], v[62:63], v[36:37], v[50:51] op_sel:[0,0,0] op_sel_hi:[0,1,1] neg_lo:[0,0,1]
    v_cvt_pk_bf16_f32 v55, v64, v65
    ds_write_b32 v6, v55 offset:14144
    v_cvt_pk_bf16_f32 v56, v66, -v67
    ds_write_b32 v6, v56 offset:2992
    v_pk_mul_f32 v[48:49], v[76:77], v[38:39] op_sel:[1,1] op_sel_hi:[1,0]
    v_pk_fma_f32 v[88:89], v[76:77], v[38:39], v[48:49] op_sel:[0,0,0] op_sel_hi:[0,1,1] neg_lo:[0,0,1]
    v_cvt_pk_bf16_f32 v57, v88, -v89
    ds_write_b32 v6, v57 offset:3264
    v_pk_mul_f32 v[46:47], v[78:79], v[38:39] op_sel:[1,1] op_sel_hi:[1,0]
    v_pk_fma_f32 v[66:67], v[78:79], v[38:39], v[46:47] op_sel:[0,0,0] op_sel_hi:[0,1,1] neg_lo:[0,0,1]
    v_pk_mul_f32 v[50:51], v[64:65], v[36:37] op_sel:[1,1] op_sel_hi:[1,0]
    v_pk_fma_f32 v[62:63], v[64:65], v[36:37], v[50:51] op_sel:[0,0,0] op_sel_hi:[0,1,1] neg_lo:[0,0,1]
    v_cvt_pk_bf16_f32 v54, v62, v63
    ds_write_b32 v6, v54 offset:14416
    v_cvt_pk_bf16_f32 v55, v66, -v67
    ds_write_b32 v6, v55 offset:3536
    v_pk_mul_f32 v[48:49], v[80:81], v[38:39] op_sel:[1,1] op_sel_hi:[1,0]
    v_pk_fma_f32 v[90:91], v[80:81], v[38:39], v[48:49] op_sel:[0,0,0] op_sel_hi:[0,1,1] neg_lo:[0,0,1]
    v_cvt_pk_bf16_f32 v56, v90, -v91
    ds_write_b32 v6, v56 offset:3808
    v_pk_mul_f32 v[46:47], v[82:83], v[38:39] op_sel:[1,1] op_sel_hi:[1,0]
    v_pk_fma_f32 v[66:67], v[82:83], v[38:39], v[46:47] op_sel:[0,0,0] op_sel_hi:[0,1,1] neg_lo:[0,0,1]
    v_pk_mul_f32 v[50:51], v[62:63], v[36:37] op_sel:[1,1] op_sel_hi:[1,0]
    v_pk_fma_f32 v[64:65], v[62:63], v[36:37], v[50:51] op_sel:[0,0,0] op_sel_hi:[0,1,1] neg_lo:[0,0,1]
    v_cvt_pk_bf16_f32 v57, v64, v65
    ds_write_b32 v6, v57 offset:14688
    v_cvt_pk_bf16_f32 v54, v66, -v67
    ds_write_b32 v6, v54 offset:4080
    v_pk_mul_f32 v[48:49], v[60:61], v[42:43] op_sel:[1,1] op_sel_hi:[1,0]
    v_pk_fma_f32 v[92:93], v[60:61], v[42:43], v[48:49] op_sel:[0,0,0] op_sel_hi:[0,1,1] neg_lo:[0,0,1]
    v_cvt_pk_bf16_f32 v55, v92, -v93
    ds_write_b32 v6, v55 offset:4352
    v_pk_mul_f32 v[46:47], v[72:73], v[42:43] op_sel:[1,1] op_sel_hi:[1,0]
    v_pk_fma_f32 v[66:67], v[72:73], v[42:43], v[46:47] op_sel:[0,0,0] op_sel_hi:[0,1,1] neg_lo:[0,0,1]
    v_pk_mul_f32 v[50:51], v[64:65], v[36:37] op_sel:[1,1] op_sel_hi:[1,0]
    v_pk_fma_f32 v[62:63], v[64:65], v[36:37], v[50:51] op_sel:[0,0,0] op_sel_hi:[0,1,1] neg_lo:[0,0,1]
    v_cvt_pk_bf16_f32 v56, v62, v63
    ds_write_b32 v6, v56 offset:14960
    v_cvt_pk_bf16_f32 v57, v66, -v67
    ds_write_b32 v6, v57 offset:4624
    v_pk_mul_f32 v[48:49], v[76:77], v[42:43] op_sel:[1,1] op_sel_hi:[1,0]
    v_pk_fma_f32 v[94:95], v[76:77], v[42:43], v[48:49] op_sel:[0,0,0] op_sel_hi:[0,1,1] neg_lo:[0,0,1]
    v_cvt_pk_bf16_f32 v54, v94, -v95
    ds_write_b32 v6, v54 offset:4896
    v_pk_mul_f32 v[46:47], v[80:81], v[42:43] op_sel:[1,1] op_sel_hi:[1,0]
    v_pk_fma_f32 v[66:67], v[80:81], v[42:43], v[46:47] op_sel:[0,0,0] op_sel_hi:[0,1,1] neg_lo:[0,0,1]
    v_pk_mul_f32 v[50:51], v[62:63], v[36:37] op_sel:[1,1] op_sel_hi:[1,0]
    v_pk_fma_f32 v[64:65], v[62:63], v[36:37], v[50:51] op_sel:[0,0,0] op_sel_hi:[0,1,1] neg_lo:[0,0,1]
    v_cvt_pk_bf16_f32 v55, v64, v65
    ds_write_b32 v6, v55 offset:15232
    v_cvt_pk_bf16_f32 v56, v66, -v67
    ds_write_b32 v6, v56 offset:5168
    v_pk_mul_f32 v[48:49], v[84:85], v[42:43] op_sel:[1,1] op_sel_hi:[1,0]
    v_pk_fma_f32 v[96:97], v[84:85], v[42:43], v[48:49] op_sel:[0,0,0] op_sel_hi:[0,1,1] neg_lo:[0,0,1]
    v_cvt_pk_bf16_f32 v57, v96, -v97
    ds_write_b32 v6, v57 offset:5440
    v_pk_mul_f32 v[46:47], v[86:87], v[42:43] op_sel:[1,1] op_sel_hi:[1,0]
    v_pk_fma_f32 v[66:67], v[86:87], v[42:43], v[46:47] op_sel:[0,0,0] op_sel_hi:[0,1,1] neg_lo:[0,0,1]
    v_cvt_pk_bf16_f32 v54, v66, -v67
    ds_write_b32 v6, v54 offset:5712
    v_pk_mul_f32 v[48:49], v[88:89], v[42:43] op_sel:[1,1] op_sel_hi:[1,0]
    v_pk_fma_f32 v[98:99], v[88:89], v[42:43], v[48:49] op_sel:[0,0,0] op_sel_hi:[0,1,1] neg_lo:[0,0,1]
    v_cvt_pk_bf16_f32 v55, v98, -v99
    ds_write_b32 v6, v55 offset:5984
    v_pk_mul_f32 v[46:47], v[90:91], v[42:43] op_sel:[1,1] op_sel_hi:[1,0]
    v_pk_fma_f32 v[66:67], v[90:91], v[42:43], v[46:47] op_sel:[0,0,0] op_sel_hi:[0,1,1] neg_lo:[0,0,1]
    v_cvt_pk_bf16_f32 v56, v66, -v67
    ds_write_b32 v6, v56 offset:6256
    v_pk_mul_f32 v[48:49], v[60:61], v[44:45] op_sel:[1,1] op_sel_hi:[1,0]
    v_pk_fma_f32 v[100:101], v[60:61], v[44:45], v[48:49] op_sel:[0,0,0] op_sel_hi:[0,1,1] neg_lo:[0,0,1]
    v_cvt_pk_bf16_f32 v57, v100, -v101
    ds_write_b32 v6, v57 offset:6800
    v_pk_mul_f32 v[46:47], v[84:85], v[44:45] op_sel:[1,1] op_sel_hi:[1,0]
    v_pk_fma_f32 v[102:103], v[84:85], v[44:45], v[46:47] op_sel:[0,0,0] op_sel_hi:[0,1,1] neg_lo:[0,0,1]
    v_cvt_pk_bf16_f32 v54, v102, -v103
    ds_write_b32 v6, v54 offset:7072
    v_pk_mul_f32 v[48:49], v[92:93], v[44:45] op_sel:[1,1] op_sel_hi:[1,0]
    v_pk_fma_f32 v[104:105], v[92:93], v[44:45], v[48:49] op_sel:[0,0,0] op_sel_hi:[0,1,1] neg_lo:[0,0,1]
    v_cvt_pk_bf16_f32 v55, v104, -v105
    ds_write_b32 v6, v55 offset:7344
    v_pk_mul_f32 v[46:47], v[96:97], v[44:45] op_sel:[1,1] op_sel_hi:[1,0]
    v_pk_fma_f32 v[106:107], v[96:97], v[44:45], v[46:47] op_sel:[0,0,0] op_sel_hi:[0,1,1] neg_lo:[0,0,1]
    v_cvt_pk_bf16_f32 v56, v106, -v107
    ds_write_b32 v6, v56 offset:7616
    v_pk_mul_f32 v[48:49], v[76:77], v[44:45] op_sel:[1,1] op_sel_hi:[1,0]
    v_pk_fma_f32 v[68:69], v[76:77], v[44:45], v[48:49] op_sel:[0,0,0] op_sel_hi:[0,1,1] neg_lo:[0,0,1]
    v_cvt_pk_bf16_f32 v57, v68, -v69
    ds_write_b32 v6, v57 offset:7888
    v_pk_mul_f32 v[46:47], v[88:89], v[44:45] op_sel:[1,1] op_sel_hi:[1,0]
    v_pk_fma_f32 v[66:67], v[88:89], v[44:45], v[46:47] op_sel:[0,0,0] op_sel_hi:[0,1,1] neg_lo:[0,0,1]
    v_cvt_pk_bf16_f32 v54, v66, -v67
    ds_write_b32 v6, v54 offset:8160
    v_pk_mul_f32 v[48:49], v[94:95], v[44:45] op_sel:[1,1] op_sel_hi:[1,0]
    v_pk_fma_f32 v[68:69], v[94:95], v[44:45], v[48:49] op_sel:[0,0,0] op_sel_hi:[0,1,1] neg_lo:[0,0,1]
    v_cvt_pk_bf16_f32 v55, v68, -v69
    ds_write_b32 v6, v55 offset:8432
    v_pk_mul_f32 v[46:47], v[98:99], v[44:45] op_sel:[1,1] op_sel_hi:[1,0]
    v_pk_fma_f32 v[66:67], v[98:99], v[44:45], v[46:47] op_sel:[0,0,0] op_sel_hi:[0,1,1] neg_lo:[0,0,1]
    v_cvt_pk_bf16_f32 v56, v66, -v67
    ds_write_b32 v6, v56 offset:8704
    v_pk_mul_f32 v[48:49], v[60:61], v[40:41] op_sel:[1,1] op_sel_hi:[1,0]
    v_pk_fma_f32 v[108:109], v[60:61], v[40:41], v[48:49] op_sel:[0,0,0] op_sel_hi:[0,1,1] neg_lo:[0,0,1]
    v_cvt_pk_bf16_f32 v57, v108, -v109
    ds_write_b32 v6, v57 offset:8976
    v_pk_mul_f32 v[46:47], v[84:85], v[40:41] op_sel:[1,1] op_sel_hi:[1,0]
    v_pk_fma_f32 v[66:67], v[84:85], v[40:41], v[46:47] op_sel:[0,0,0] op_sel_hi:[0,1,1] neg_lo:[0,0,1]
    v_cvt_pk_bf16_f32 v54, v66, -v67
    ds_write_b32 v6, v54 offset:9248
    v_pk_mul_f32 v[48:49], v[92:93], v[40:41] op_sel:[1,1] op_sel_hi:[1,0]
    v_pk_fma_f32 v[68:69], v[92:93], v[40:41], v[48:49] op_sel:[0,0,0] op_sel_hi:[0,1,1] neg_lo:[0,0,1]
    v_cvt_pk_bf16_f32 v55, v68, -v69
    ds_write_b32 v6, v55 offset:9520
    v_pk_mul_f32 v[46:47], v[96:97], v[40:41] op_sel:[1,1] op_sel_hi:[1,0]
    v_pk_fma_f32 v[66:67], v[96:97], v[40:41], v[46:47] op_sel:[0,0,0] op_sel_hi:[0,1,1] neg_lo:[0,0,1]
    v_cvt_pk_bf16_f32 v56, v66, -v67
    ds_write_b32 v6, v56 offset:9792
    v_pk_mul_f32 v[48:49], v[100:101], v[40:41] op_sel:[1,1] op_sel_hi:[1,0]
    v_pk_fma_f32 v[68:69], v[100:101], v[40:41], v[48:49] op_sel:[0,0,0] op_sel_hi:[0,1,1] neg_lo:[0,0,1]
    v_cvt_pk_bf16_f32 v57, v68, -v69
    ds_write_b32 v6, v57 offset:10064
    v_pk_mul_f32 v[46:47], v[102:103], v[40:41] op_sel:[1,1] op_sel_hi:[1,0]
    v_pk_fma_f32 v[66:67], v[102:103], v[40:41], v[46:47] op_sel:[0,0,0] op_sel_hi:[0,1,1] neg_lo:[0,0,1]
    v_cvt_pk_bf16_f32 v54, v66, -v67
    ds_write_b32 v6, v54 offset:10336
    v_pk_mul_f32 v[48:49], v[104:105], v[40:41] op_sel:[1,1] op_sel_hi:[1,0]
    v_pk_fma_f32 v[68:69], v[104:105], v[40:41], v[48:49] op_sel:[0,0,0] op_sel_hi:[0,1,1] neg_lo:[0,0,1]
    v_cvt_pk_bf16_f32 v55, v68, -v69
    ds_write_b32 v6, v55 offset:10608
    v_pk_mul_f32 v[46:47], v[106:107], v[40:41] op_sel:[1,1] op_sel_hi:[1,0]
    v_pk_fma_f32 v[66:67], v[106:107], v[40:41], v[46:47] op_sel:[0,0,0] op_sel_hi:[0,1,1] neg_lo:[0,0,1]
    v_cvt_pk_bf16_f32 v56, v66, -v67
    ds_write_b32 v6, v56 offset:10880
    v_pk_mul_f32 v[48:49], v[108:109], v[40:41] op_sel:[1,1] op_sel_hi:[1,0]
    v_pk_fma_f32 v[68:69], v[108:109], v[40:41], v[48:49] op_sel:[0,0,0] op_sel_hi:[0,1,1] neg_lo:[0,0,1]
    v_cvt_pk_bf16_f32 v57, v68, -v69
    ds_write_b32 v6, v57 offset:6528
    s_waitcnt lgkmcnt(0)
    ds_read_b128 v[60:63], v7 offset:0
    ds_read_b128 v[64:67], v7 offset:4352
    ds_read_b128 v[68:71], v7 offset:6800
    ds_read_b128 v[72:75], v7 offset:11152
    ds_read_b128 v[76:79], v7 offset:64
    ds_read_b128 v[80:83], v7 offset:4416
    ds_read_b128 v[84:87], v7 offset:6864
    ds_read_b128 v[88:91], v7 offset:11216
    ds_read_b128 v[92:95], v7 offset:128
    ds_read_b128 v[96:99], v7 offset:4480
    ds_read_b128 v[100:103], v7 offset:6928
    ds_read_b128 v[104:107], v7 offset:11280
    ds_read_b128 v[108:111], v7 offset:192
    ds_read_b128 v[112:115], v7 offset:4544
    ds_read_b128 v[116:119], v7 offset:6992
    ds_read_b128 v[120:123], v7 offset:11344
    s_waitcnt lgkmcnt(12)
    v_mfma_f32_16x16x32_bf16 v[16:19], v[60:63], v[72:75], v[16:19]
    v_mfma_f32_16x16x32_bf16 v[20:23], v[64:67], v[72:75], v[20:23]
    v_mfma_f32_16x16x32_bf16 v[24:27], v[68:71], v[72:75], v[24:27]
    s_waitcnt lgkmcnt(8)
    v_mfma_f32_16x16x32_bf16 v[16:19], v[76:79], v[88:91], v[16:19]
    v_mfma_f32_16x16x32_bf16 v[20:23], v[80:83], v[88:91], v[20:23]
    v_mfma_f32_16x16x32_bf16 v[24:27], v[84:87], v[88:91], v[24:27]
    s_waitcnt lgkmcnt(4)
    v_mfma_f32_16x16x32_bf16 v[16:19], v[92:95], v[104:107], v[16:19]
    v_mfma_f32_16x16x32_bf16 v[20:23], v[96:99], v[104:107], v[20:23]
    v_mfma_f32_16x16x32_bf16 v[24:27], v[100:103], v[104:107], v[24:27]
    s_waitcnt lgkmcnt(0)
    v_mfma_f32_16x16x32_bf16 v[16:19], v[108:111], v[120:123], v[16:19]
    v_mfma_f32_16x16x32_bf16 v[20:23], v[112:115], v[120:123], v[20:23]
    v_mfma_f32_16x16x32_bf16 v[24:27], v[116:119], v[120:123], v[24:27]
    s_cmp_eq_u32 s21, 0
    s_cbranch_scc1 km_kernel_kg0
    s_nop 6
    ds_write_b128 v128, v[16:19] offset:10240
    ds_write_b128 v128, v[20:23] offset:11264
    ds_write_b128 v128, v[24:27] offset:12288
    v_mov_b32 v30, s41
    v_mov_b32 v31, 1
    s_mov_b64 exec, 1
    ds_add_u32 v30, v31
    s_mov_b64 exec, -1
    s_setprio 0
    s_branch km_kernel_wpre
km_kernel_kg0:
    v_mov_b32 v46, s41
    s_mov_b32 s17, 262144
lw_7:
    ds_read_b32 v47, v46
    s_sub_u32 s17, s17, 1
    s_waitcnt lgkmcnt(0)
    v_readfirstlane_b32 s16, v47
    s_cmp_eq_u32 s17, 0
    s_cbranch_scc1 lwd_8
    s_cmp_ge_u32 s16, 1
    s_cbranch_scc1 lwd_8
    s_sleep 1
    s_branch lw_7
lwd_8:
    ds_read_b128 v[48:51], v128 offset:10240
    ds_read_b128 v[52:55], v128 offset:11264
    ds_read_b128 v[56:59], v128 offset:12288
    s_mov_b64 exec, 0xffff
    ds_write_b32 v129, v144 offset:4224
    ds_write_b32 v129, v144 offset:8384
    s_mov_b64 exec, -1
    s_waitcnt lgkmcnt(2)
    v_add_f32 v16, v16, v48
    v_add_f32 v17, v17, v49
    v_add_f32 v18, v18, v50
    v_add_f32 v19, v19, v51
    v_add_f32 v20, v20, v52
    v_add_f32 v21, v21, v53
    v_add_f32 v22, v22, v54
    v_add_f32 v23, v23, v55
    v_add_f32 v24, v24, v56
    v_add_f32 v25, v25, v57
    v_add_f32 v26, v26, v58
    v_add_f32 v27, v27, v59
    v_cvt_pk_bf16_f32 v16, v16, v17
    v_cvt_pk_bf16_f32 v18, v18, v19
    ds_write_b16 v132, v16 offset:0
    ds_write_b16_d16_hi v132, v16 offset:2
    ds_write_b16 v132, v18 offset:4
    ds_write_b16_d16_hi v132, v18 offset:6
    v_cvt_pk_bf16_f32 v20, v20, v21
    v_cvt_pk_bf16_f32 v22, v22, v23
    ds_write_b16 v133, v20 offset:512
    ds_write_b16_d16_hi v133, v20 offset:516
    ds_write_b16 v133, v22 offset:520
    ds_write_b16_d16_hi v133, v22 offset:524
    v_cvt_pk_bf16_f32 v24, v24, v25
    v_cvt_pk_bf16_f32 v26, v26, v27
    ds_write_b16 v134, v24 offset:1024
    ds_write_b16_d16_hi v134, v24 offset:1280
    ds_write_b16 v134, v26 offset:1536
    ds_write_b16_d16_hi v134, v26 offset:1792
    ds_read_u16 v60, v142 offset:3840
    ds_read_u16 v61, v143 offset:3840
    ds_read_u16 v62, v142 offset:3584
    ds_read_u16 v63, v143 offset:3584
    ds_read_u16 v64, v142 offset:3328
    ds_read_u16 v65, v143 offset:3328
    ds_read_u16 v66, v142 offset:3072
    ds_read_u16 v67, v143 offset:3072
    ds_read_u16 v68, v142 offset:2816
    ds_read_u16 v69, v143 offset:2816
    ds_read_u16 v70, v142 offset:2560
    ds_read_u16 v71, v143 offset:2560
    ds_read_u16 v72, v142 offset:2304
    ds_read_u16 v73, v143 offset:2304
    ds_read_u16 v74, v142 offset:2048
    ds_read_u16 v75, v143 offset:2048
    ds_read_u16 v76, v140 offset:1792
    ds_read_u16 v77, v141 offset:1792
    ds_read_u16 v78, v140 offset:1536
    ds_read_u16 v79, v141 offset:1536
    ds_read_u16 v80, v140 offset:1280
    ds_read_u16 v81, v141 offset:1280
    ds_read_u16 v82, v140 offset:1024
    ds_read_u16 v83, v141 offset:1024
    ds_read_u16 v84, v138 offset:768
    ds_read_u16 v85, v139 offset:768
    ds_read_u16 v86, v138 offset:512
    ds_read_u16 v87, v139 offset:512
    ds_read_u16 v88, v136 offset:256
    ds_read_u16 v89, v137 offset:256
    ds_read_u16 v90, v136 offset:0
    ds_read_u16 v91, v137 offset:0
    s_waitcnt lgkmcnt(15)
    v_lshl_or_b32 v60, v61, 16, v60
    ds_write_b32 v129, v60 offset:128
    s_waitcnt lgkmcnt(15)
    v_lshl_or_b32 v62, v63, 16, v62
    ds_write_b32 v129, v62 offset:384
    s_waitcnt lgkmcnt(15)
    v_lshl_or_b32 v64, v65, 16, v64
    ds_write_b32 v129, v64 offset:640
    s_waitcnt lgkmcnt(15)
    v_lshl_or_b32 v66, v67, 16, v66
    ds_write_b32 v129, v66 offset:896
    s_waitcnt lgkmcnt(15)
    v_lshl_or_b32 v68, v69, 16, v68
    ds_write_b32 v129, v68 offset:1152
    s_waitcnt lgkmcnt(15)
    v_lshl_or_b32 v70, v71, 16, v70
    ds_write_b32 v129, v70 offset:1408
    s_waitcnt lgkmcnt(15)
    v_lshl_or_b32 v72, v73, 16, v72
    ds_write_b32 v129, v72 offset:1664
    s_waitcnt lgkmcnt(15)
    v_lshl_or_b32 v74, v75, 16, v74
    ds_write_b32 v129, v74 offset:1920
    s_waitcnt lgkmcnt(15)
    v_lshl_or_b32 v76, v77, 16, v76
    ds_write_b32 v129, v76 offset:2176
    s_waitcnt lgkmcnt(15)
    v_lshl_or_b32 v78, v79, 16, v78
    ds_write_b32 v129, v78 offset:2432
    s_waitcnt lgkmcnt(15)
    v_lshl_or_b32 v80, v81, 16, v80
    ds_write_b32 v129, v80 offset:2688
    s_waitcnt lgkmcnt(15)
    v_lshl_or_b32 v82, v83, 16, v82
    ds_write_b32 v129, v82 offset:2944
    s_waitcnt lgkmcnt(15)
    v_lshl_or_b32 v84, v85, 16, v84
    ds_write_b32 v129, v84 offset:3200
    s_waitcnt lgkmcnt(15)
    v_lshl_or_b32 v86, v87, 16, v86
    ds_write_b32 v129, v86 offset:3456
    s_waitcnt lgkmcnt(15)
    v_lshl_or_b32 v88, v89, 16, v88
    ds_write_b32 v129, v88 offset:3712
    s_waitcnt lgkmcnt(15)
    v_lshl_or_b32 v90, v91, 16, v90
    ds_write_b32 v129, v90 offset:3968
    ds_read_b128 v[60:63], v128 offset:128
    ds_read_b32 v64, v128 offset:144
    ds_read_b128 v[72:75], v128 offset:1152
    ds_read_b32 v76, v128 offset:1168
    ds_read_b128 v[84:87], v128 offset:2176
    ds_read_b32 v88, v128 offset:2192
    ds_read_b128 v[96:99], v128 offset:3200
    ds_read_b32 v100, v128 offset:3216
    v_mov_b32 v0, v150
    v_mov_b32 v2, v151
    v_mov_b32 v5, v152
    v_mov_b32 v6, v153
    v_mov_b32 v7, v154
    v_mov_b32 v4, v155
    v_mov_b32 v43, v156
    v_mov_b32 v44, v157
    s_lshl_b32 s40, s40, 16
    s_waitcnt lgkmcnt(6)
    v_alignbit_b32 v68, v61, v60, 16
    v_alignbit_b32 v69, v62, v61, 16
    v_alignbit_b32 v70, v63, v62, 16
    v_alignbit_b32 v71, v64, v63, 16
    ds_write_b128 v128, v[68:71] offset:4288
    s_waitcnt lgkmcnt(5)
    v_alignbit_b32 v80, v73, v72, 16
    v_alignbit_b32 v81, v74, v73, 16
    v_alignbit_b32 v82, v75, v74, 16
    v_alignbit_b32 v83, v76, v75, 16
    ds_write_b128 v128, v[80:83] offset:5312
    s_waitcnt lgkmcnt(4)
    v_alignbit_b32 v92, v85, v84, 16
    v_alignbit_b32 v93, v86, v85, 16
    v_alignbit_b32 v94, v87, v86, 16
    v_alignbit_b32 v95, v88, v87, 16
    ds_write_b128 v128, v[92:95] offset:6336
    s_waitcnt lgkmcnt(3)
    v_alignbit_b32 v104, v97, v96, 16
    v_alignbit_b32 v105, v98, v97, 16
    v_alignbit_b32 v106, v99, v98, 16
    v_alignbit_b32 v107, v100, v99, 16
    ds_write_b128 v128, v[104:107] offset:7360
    v_mov_b32 v46, 163456
    v_mov_b32 v47, 1
    s_mov_b64 exec, 1
    ds_add_u32 v46, v47
    s_mov_b64 exec, -1
    v_mov_b32 v46, 163508
    s_mov_b32 s17, 262144
lw_9:
    ds_read_b32 v47, v46
    s_sub_u32 s17, s17, 1
    s_waitcnt lgkmcnt(0)
    v_readfirstlane_b32 s16, v47
    s_cmp_eq_u32 s17, 0
    s_cbranch_scc1 lwd_10
    s_cmp_ge_u32 s16, 4
    s_cbranch_scc1 lwd_10
    s_sleep 1
    s_branch lw_9
lwd_10:
    ds_read_b64 v[48:49], v43 offset:0
    ds_read_b64 v[50:51], v43 offset:512
    ds_read_b64 v[52:53], v43 offset:1024
    ds_read_b64 v[54:55], v43 offset:1536
    ds_read_b64 v[56:57], v43 offset:2048
    ds_read_b64 v[58:59], v43 offset:2560
    ds_read_b64 v[60:61], v43 offset:3072
    ds_read_b64 v[62:63], v43 offset:3584
    ds_read2_b32 v[104:105], v0 offset0:128 offset1:129
    ds_read2_b32 v[106:107], v0 offset0:130 offset1:131
    ds_read2_b32 v[108:109], v0 offset0:0 offset1:1
    ds_read2_b32 v[110:111], v0 offset0:2 offset1:3
    ds_read2_b32 v[112:113], v2 offset0:128 offset1:129
    ds_read2_b32 v[114:115], v2 offset0:130 offset1:131
    ds_read2_b32 v[116:117], v2 offset0:0 offset1:1
    ds_read2_b32 v[118:119], v2 offset0:2 offset1:3
    ds_read2_b32 v[120:121], v5 offset0:128 offset1:129
    ds_read2_b32 v[122:123], v5 offset0:130 offset1:131
    ds_read2_b32 v[124:125], v5 offset0:0 offset1:1
    ds_read2_b32 v[126:127], v5 offset0:2 offset1:3
    ds_read2_b32 v[128:129], v6 offset0:128 offset1:129
    ds_read2_b32 v[130:131], v6 offset0:130 offset1:131
    ds_read2_b32 v[132:133], v6 offset0:0 offset1:1
    ds_read2_b32 v[134:135], v6 offset0:2 offset1:3
    s_waitcnt lgkmcnt(15)
    v_lshlrev_b32 v8, 16, v48
    v_and_b32 v9, 0xffff0000, v48
    v_lshlrev_b32 v10, 16, v49
    v_and_b32 v11, 0xffff0000, v49
    v_lshlrev_b32 v12, 16, v50
    v_and_b32 v13, 0xffff0000, v50
    v_lshlrev_b32 v14, 16, v51
    v_and_b32 v15, 0xffff0000, v51
    v_lshlrev_b32 v16, 16, v52
    v_and_b32 v17, 0xffff0000, v52
    v_lshlrev_b32 v18, 16, v53
    v_and_b32 v19, 0xffff0000, v53
    v_lshlrev_b32 v20, 16, v54
    v_and_b32 v21, 0xffff0000, v54
    v_lshlrev_b32 v22, 16, v55
    v_and_b32 v23, 0xffff0000, v55
    v_lshlrev_b32 v24, 16, v56
    v_and_b32 v25, 0xffff0000, v56
    v_lshlrev_b32 v26, 16, v57
    v_and_b32 v27, 0xffff0000, v57
    v_lshlrev_b32 v28, 16, v58
    v_and_b32 v29, 0xffff0000, v58
    v_lshlrev_b32 v30, 16, v59
    v_and_b32 v31, 0xffff0000, v59
    v_lshlrev_b32 v32, 16, v60
    v_and_b32 v33, 0xffff0000, v60
    v_lshlrev_b32 v34, 16, v61
    v_and_b32 v35, 0xffff0000, v61
    v_lshlrev_b32 v36, 16, v62
    v_and_b32 v37, 0xffff0000, v62
    v_lshlrev_b32 v38, 16, v63
    v_and_b32 v39, 0xffff0000, v63
    v_mov_b32 v46, 163360
    s_mov_b32 s17, 262144
lw_11:
    ds_read_b32 v47, v46
    s_sub_u32 s17, s17, 1
    s_waitcnt lgkmcnt(0)
    v_readfirstlane_b32 s16, v47
    s_cmp_eq_u32 s17, 0
    s_cbranch_scc1 lwd_12
    s_cmp_ge_u32 s16, 4
    s_cbranch_scc1 lwd_12
    s_sleep 1
    s_branch lw_11
lwd_12:
    s_setprio 2
    ds_read_b64 v[64:65], v44 offset:0
    ds_read_b64 v[66:67], v44 offset:512
    ds_read_b64 v[68:69], v44 offset:1024
    ds_read_b64 v[70:71], v44 offset:1536
    ds_read_b64 v[72:73], v44 offset:2048
    ds_read_b64 v[74:75], v44 offset:2560
    ds_read_b64 v[76:77], v44 offset:3072
    ds_read_b64 v[78:79], v44 offset:3584
    ds_read_b128 v[136:139], v7 offset:0
    ds_read_b128 v[140:143], v7 offset:512
    ds_read_b128 v[144:147], v7 offset:1024
    ds_read_b128 v[148:151], v7 offset:1536
    ds_read_b128 v[152:155], v7 offset:2048
    ds_read_b128 v[156:159], v7 offset:2560
    ds_read_b128 v[160:163], v7 offset:3072
    ds_read_b128 v[164:167], v7 offset:3584
    v_subrev_u32 v0, 64, v0
    v_subrev_u32 v2, 64, v2
    v_subrev_u32 v5, 64, v5
    v_subrev_u32 v6, 64, v6
    v_subrev_u32 v7, 64, v7
    s_waitcnt lgkmcnt(15)
    v_lshlrev_b32 v46, 16, v64
    v_and_b32 v47, 0xffff0000, v64
    v_fmac_f32 v8, s40, v46
    v_fmac_f32 v9, s40, v47
    v_lshlrev_b32 v46, 16, v65
    v_and_b32 v47, 0xffff0000, v65
    v_fmac_f32 v10, s40, v46
    v_fmac_f32 v11, s40, v47
    s_waitcnt lgkmcnt(14)
    v_lshlrev_b32 v46, 16, v66
    v_and_b32 v47, 0xffff0000, v66
    v_fmac_f32 v12, s40, v46
    v_fmac_f32 v13, s40, v47
    v_lshlrev_b32 v46, 16, v67
    v_and_b32 v47, 0xffff0000, v67
    v_fmac_f32 v14, s40, v46
    v_fmac_f32 v15, s40, v47
    s_waitcnt lgkmcnt(13)
    v_lshlrev_b32 v46, 16, v68
    v_and_b32 v47, 0xffff0000, v68
    v_fmac_f32 v16, s40, v46
    v_fmac_f32 v17, s40, v47
    v_lshlrev_b32 v46, 16, v69
    v_and_b32 v47, 0xffff0000, v69
    v_fmac_f32 v18, s40, v46
    v_fmac_f32 v19, s40, v47
    s_waitcnt lgkmcnt(12)
    v_lshlrev_b32 v46, 16, v70
    v_and_b32 v47, 0xffff0000, v70
    v_fmac_f32 v20, s40, v46
    v_fmac_f32 v21, s40, v47
    v_lshlrev_b32 v46, 16, v71
    v_and_b32 v47, 0xffff0000, v71
    v_fmac_f32 v22, s40, v46
    v_fmac_f32 v23, s40, v47
    s_waitcnt lgkmcnt(11)
    v_lshlrev_b32 v46, 16, v72
    v_and_b32 v47, 0xffff0000, v72
    v_fmac_f32 v24, s40, v46
    v_fmac_f32 v25, s40, v47
    v_lshlrev_b32 v46, 16, v73
    v_and_b32 v47, 0xffff0000, v73
    v_fmac_f32 v26, s40, v46
    v_fmac_f32 v27, s40, v47
    s_waitcnt lgkmcnt(10)
    v_lshlrev_b32 v46, 16, v74
    v_and_b32 v47, 0xffff0000, v74
    v_fmac_f32 v28, s40, v46
    v_fmac_f32 v29, s40, v47
    v_lshlrev_b32 v46, 16, v75
    v_and_b32 v47, 0xffff0000, v75
    v_fmac_f32 v30, s40, v46
    v_fmac_f32 v31, s40, v47
    s_waitcnt lgkmcnt(9)
    v_lshlrev_b32 v46, 16, v76
    v_and_b32 v47, 0xffff0000, v76
    v_fmac_f32 v32, s40, v46
    v_fmac_f32 v33, s40, v47
    v_lshlrev_b32 v46, 16, v77
    v_and_b32 v47, 0xffff0000, v77
    v_fmac_f32 v34, s40, v46
    v_fmac_f32 v35, s40, v47
    s_waitcnt lgkmcnt(8)
    v_lshlrev_b32 v46, 16, v78
    v_and_b32 v47, 0xffff0000, v78
    v_fmac_f32 v36, s40, v46
    v_fmac_f32 v37, s40, v47
    v_lshlrev_b32 v46, 16, v79
    v_and_b32 v47, 0xffff0000, v79
    v_fmac_f32 v38, s40, v46
    v_fmac_f32 v39, s40, v47
    s_mov_b32 s25, 4
km_kernel_cloop:
    s_waitcnt lgkmcnt(0)
    v_mfma_f32_16x16x32_bf16 v[36:39], v[104:107], v[164:167], v[36:39]
    ds_read2_b32 v[40:41], v0 offset0:128 offset1:129
    v_mfma_f32_16x16x32_bf16 v[36:39], v[108:111], v[160:163], v[36:39]
    ds_read2_b32 v[42:43], v0 offset0:130 offset1:131
    v_mfma_f32_16x16x32_bf16 v[36:39], v[112:115], v[156:159], v[36:39]
    ds_read_b128 v[72:75], v7 offset:0
    v_mfma_f32_16x16x32_bf16 v[36:39], v[116:119], v[152:155], v[36:39]
    ds_read2_b32 v[44:45], v0 offset0:0 offset1:1
    v_mfma_f32_16x16x32_bf16 v[36:39], v[120:123], v[148:151], v[36:39]
    ds_read2_b32 v[46:47], v0 offset0:2 offset1:3
    v_mfma_f32_16x16x32_bf16 v[36:39], v[124:127], v[144:147], v[36:39]
    ds_read_b128 v[76:79], v7 offset:512
    v_mfma_f32_16x16x32_bf16 v[36:39], v[128:131], v[140:143], v[36:39]
    ds_read2_b32 v[48:49], v2 offset0:128 offset1:129
    v_mfma_f32_16x16x32_bf16 v[36:39], v[132:135], v[136:139], v[36:39]
    ds_read2_b32 v[50:51], v2 offset0:130 offset1:131
    v_mfma_f32_16x16x32_bf16 v[32:35], v[104:107], v[160:163], v[32:35]
    ds_read_b128 v[80:83], v7 offset:1024
    v_mfma_f32_16x16x32_bf16 v[32:35], v[108:111], v[156:159], v[32:35]
    ds_read2_b32 v[52:53], v2 offset0:0 offset1:1
    v_mfma_f32_16x16x32_bf16 v[32:35], v[112:115], v[152:155], v[32:35]
    ds_read2_b32 v[54:55], v2 offset0:2 offset1:3
    v_mfma_f32_16x16x32_bf16 v[32:35], v[116:119], v[148:151], v[32:35]
    ds_read_b128 v[84:87], v7 offset:1536
    v_mfma_f32_16x16x32_bf16 v[32:35], v[120:123], v[144:147], v[32:35]
    ds_read2_b32 v[56:57], v5 offset0:128 offset1:129
    v_mfma_f32_16x16x32_bf16 v[32:35], v[124:127], v[140:143], v[32:35]
    ds_read2_b32 v[58:59], v5 offset0:130 offset1:131
    v_mfma_f32_16x16x32_bf16 v[32:35], v[128:131], v[136:139], v[32:35]
    ds_read_b128 v[88:91], v7 offset:2048
    v_mfma_f32_16x16x32_bf16 v[28:31], v[104:107], v[156:159], v[28:31]
    ds_read2_b32 v[60:61], v5 offset0:0 offset1:1
    v_mfma_f32_16x16x32_bf16 v[28:31], v[108:111], v[152:155], v[28:31]
    ds_read2_b32 v[62:63], v5 offset0:2 offset1:3
    v_mfma_f32_16x16x32_bf16 v[28:31], v[112:115], v[148:151], v[28:31]
    ds_read_b128 v[92:95], v7 offset:2560
    v_mfma_f32_16x16x32_bf16 v[28:31], v[116:119], v[144:147], v[28:31]
    ds_read2_b32 v[64:65], v6 offset0:128 offset1:129
    v_mfma_f32_16x16x32_bf16 v[28:31], v[120:123], v[140:143], v[28:31]
    ds_read2_b32 v[66:67], v6 offset0:130 offset1:131
    v_mfma_f32_16x16x32_bf16 v[28:31], v[124:127], v[136:139], v[28:31]
    ds_read_b128 v[96:99], v7 offset:3072
    v_mfma_f32_16x16x32_bf16 v[24:27], v[104:107], v[152:155], v[24:27]
    ds_read2_b32 v[68:69], v6 offset0:0 offset1:1
    v_mfma_f32_16x16x32_bf16 v[24:27], v[108:111], v[148:151], v[24:27]
    ds_read2_b32 v[70:71], v6 offset0:2 offset1:3
    v_mfma_f32_16x16x32_bf16 v[24:27], v[112:115], v[144:147], v[24:27]
    ds_read_b128 v[100:103], v7 offset:3584
    v_mfma_f32_16x16x32_bf16 v[24:27], v[116:119], v[140:143], v[24:27]
    v_subrev_u32 v0, 64, v0
    v_mfma_f32_16x16x32_bf16 v[24:27], v[120:123], v[136:139], v[24:27]
    v_subrev_u32 v2, 64, v2
    v_mfma_f32_16x16x32_bf16 v[20:23], v[104:107], v[148:151], v[20:23]
    v_subrev_u32 v5, 64, v5
    v_mfma_f32_16x16x32_bf16 v[20:23], v[108:111], v[144:147], v[20:23]
    v_subrev_u32 v6, 64, v6
    v_mfma_f32_16x16x32_bf16 v[20:23], v[112:115], v[140:143], v[20:23]
    v_subrev_u32 v7, 64, v7
    v_mfma_f32_16x16x32_bf16 v[20:23], v[116:119], v[136:139], v[20:23]
    v_mfma_f32_16x16x32_bf16 v[16:19], v[104:107], v[144:147], v[16:19]
    v_mfma_f32_16x16x32_bf16 v[16:19], v[108:111], v[140:143], v[16:19]
    v_mfma_f32_16x16x32_bf16 v[16:19], v[112:115], v[136:139], v[16:19]
    v_mfma_f32_16x16x32_bf16 v[12:15], v[104:107], v[140:143], v[12:15]
    v_mfma_f32_16x16x32_bf16 v[12:15], v[108:111], v[136:139], v[12:15]
    v_mfma_f32_16x16x32_bf16 v[8:11], v[104:107], v[136:139], v[8:11]
    s_waitcnt lgkmcnt(0)
    v_mfma_f32_16x16x32_bf16 v[36:39], v[40:43], v[100:103], v[36:39]
    ds_read2_b32 v[104:105], v0 offset0:128 offset1:129
    v_mfma_f32_16x16x32_bf16 v[36:39], v[44:47], v[96:99], v[36:39]
    ds_read2_b32 v[106:107], v0 offset0:130 offset1:131
    v_mfma_f32_16x16x32_bf16 v[36:39], v[48:51], v[92:95], v[36:39]
    ds_read_b128 v[136:139], v7 offset:0
    v_mfma_f32_16x16x32_bf16 v[36:39], v[52:55], v[88:91], v[36:39]
    ds_read2_b32 v[108:109], v0 offset0:0 offset1:1
    v_mfma_f32_16x16x32_bf16 v[36:39], v[56:59], v[84:87], v[36:39]
    ds_read2_b32 v[110:111], v0 offset0:2 offset1:3
    v_mfma_f32_16x16x32_bf16 v[36:39], v[60:63], v[80:83], v[36:39]
    ds_read_b128 v[140:143], v7 offset:512
    v_mfma_f32_16x16x32_bf16 v[36:39], v[64:67], v[76:79], v[36:39]
    ds_read2_b32 v[112:113], v2 offset0:128 offset1:129
    v_mfma_f32_16x16x32_bf16 v[36:39], v[68:71], v[72:75], v[36:39]
    ds_read2_b32 v[114:115], v2 offset0:130 offset1:131
    v_mfma_f32_16x16x32_bf16 v[32:35], v[40:43], v[96:99], v[32:35]
    ds_read_b128 v[144:147], v7 offset:1024
    v_mfma_f32_16x16x32_bf16 v[32:35], v[44:47], v[92:95], v[32:35]
    ds_read2_b32 v[116:117], v2 offset0:0 offset1:1
    v_mfma_f32_16x16x32_bf16 v[32:35], v[48:51], v[88:91], v[32:35]
    ds_read2_b32 v[118:119], v2 offset0:2 offset1:3
    v_mfma_f32_16x16x32_bf16 v[32:35], v[52:55], v[84:87], v[32:35]
    ds_read_b128 v[148:151], v7 offset:1536
    v_mfma_f32_16x16x32_bf16 v[32:35], v[56:59], v[80:83], v[32:35]
    ds_read2_b32 v[120:121], v5 offset0:128 offset1:129
    v_mfma_f32_16x16x32_bf16 v[32:35], v[60:63], v[76:79], v[32:35]
    ds_read2_b32 v[122:123], v5 offset0:130 offset1:131
    v_mfma_f32_16x16x32_bf16 v[32:35], v[64:67], v[72:75], v[32:35]
    ds_read_b128 v[152:155], v7 offset:2048
    v_mfma_f32_16x16x32_bf16 v[28:31], v[40:43], v[92:95], v[28:31]
    ds_read2_b32 v[124:125], v5 offset0:0 offset1:1
    v_mfma_f32_16x16x32_bf16 v[28:31], v[44:47], v[88:91], v[28:31]
    ds_read2_b32 v[126:127], v5 offset0:2 offset1:3
    v_mfma_f32_16x16x32_bf16 v[28:31], v[48:51], v[84:87], v[28:31]
    ds_read_b128 v[156:159], v7 offset:2560
    v_mfma_f32_16x16x32_bf16 v[28:31], v[52:55], v[80:83], v[28:31]
    ds_read2_b32 v[128:129], v6 offset0:128 offset1:129
    v_mfma_f32_16x16x32_bf16 v[28:31], v[56:59], v[76:79], v[28:31]
    ds_read2_b32 v[130:131], v6 offset0:130 offset1:131
    v_mfma_f32_16x16x32_bf16 v[28:31], v[60:63], v[72:75], v[28:31]
    ds_read_b128 v[160:163], v7 offset:3072
    v_mfma_f32_16x16x32_bf16 v[24:27], v[40:43], v[88:91], v[24:27]
    ds_read2_b32 v[132:133], v6 offset0:0 offset1:1
    v_mfma_f32_16x16x32_bf16 v[24:27], v[44:47], v[84:87], v[24:27]
    ds_read2_b32 v[134:135], v6 offset0:2 offset1:3
    v_mfma_f32_16x16x32_bf16 v[24:27], v[48:51], v[80:83], v[24:27]
    ds_read_b128 v[164:167], v7 offset:3584
    v_mfma_f32_16x16x32_bf16 v[24:27], v[52:55], v[76:79], v[24:27]
    v_subrev_u32 v0, 64, v0
    v_mfma_f32_16x16x32_bf16 v[24:27], v[56:59], v[72:75], v[24:27]
    v_subrev_u32 v2, 64, v2
    v_mfma_f32_16x16x32_bf16 v[20:23], v[40:43], v[84:87], v[20:23]
    v_subrev_u32 v5, 64, v5
    v_mfma_f32_16x16x32_bf16 v[20:23], v[44:47], v[80:83], v[20:23]
    v_subrev_u32 v6, 64, v6
    v_mfma_f32_16x16x32_bf16 v[20:23], v[48:51], v[76:79], v[20:23]
    v_subrev_u32 v7, 64, v7
    v_mfma_f32_16x16x32_bf16 v[20:23], v[52:55], v[72:75], v[20:23]
    v_mfma_f32_16x16x32_bf16 v[16:19], v[40:43], v[80:83], v[16:19]
    v_mfma_f32_16x16x32_bf16 v[16:19], v[44:47], v[76:79], v[16:19]
    v_mfma_f32_16x16x32_bf16 v[16:19], v[48:51], v[72:75], v[16:19]
    v_mfma_f32_16x16x32_bf16 v[12:15], v[40:43], v[76:79], v[12:15]
    v_mfma_f32_16x16x32_bf16 v[12:15], v[44:47], v[72:75], v[12:15]
    v_mfma_f32_16x16x32_bf16 v[8:11], v[40:43], v[72:75], v[8:11]
    s_sub_u32 s25, s25, 1
    s_cmp_lg_u32 s25, 0
    s_cbranch_scc1 km_kernel_cloop
    s_lshl_b32 s24, s22, 12
    s_add_u32 s24, s24, 4718592
    s_lshl_b32 s26, s3, 5
    s_add_u32 s26, s26, 19218432
    s_waitcnt lgkmcnt(0)
    s_nop 2
    v_cvt_pk_bf16_f32 v8, v8, v9
    v_cvt_pk_bf16_f32 v9, v10, v11
    v_cvt_pk_bf16_f32 v10, v12, v13
    v_cvt_pk_bf16_f32 v11, v14, v15
    s_nop 1
    v_permlane16_swap_b32 v8, v10
    v_permlane16_swap_b32 v9, v11
    buffer_store_dwordx4 v[8:11], v4, s[8:11], s24 offen offset:0 sc1
    v_cvt_pk_bf16_f32 v16, v16, v17
    v_cvt_pk_bf16_f32 v17, v18, v19
    v_cvt_pk_bf16_f32 v18, v20, v21
    v_cvt_pk_bf16_f32 v19, v22, v23
    s_nop 1
    v_permlane16_swap_b32 v16, v18
    v_permlane16_swap_b32 v17, v19
    buffer_store_dwordx4 v[16:19], v4, s[8:11], s24 offen offset:1024 sc1
    v_cvt_pk_bf16_f32 v24, v24, v25
    v_cvt_pk_bf16_f32 v25, v26, v27
    v_cvt_pk_bf16_f32 v26, v28, v29
    v_cvt_pk_bf16_f32 v27, v30, v31
    s_nop 1
    v_permlane16_swap_b32 v24, v26
    v_permlane16_swap_b32 v25, v27
    buffer_store_dwordx4 v[24:27], v4, s[8:11], s24 offen offset:2048 sc1
    v_cvt_pk_bf16_f32 v32, v32, v33
    v_cvt_pk_bf16_f32 v33, v34, v35
    v_cvt_pk_bf16_f32 v34, v36, v37
    v_cvt_pk_bf16_f32 v35, v38, v39
    s_nop 1
    v_permlane16_swap_b32 v32, v34
    v_permlane16_swap_b32 v33, v35
    buffer_store_dwordx4 v[32:35], v4, s[8:11], s24 offen offset:3072 sc1
    v_mov_b32 v40, 163328
    s_mov_b32 s17, 262144
lw_13:
    ds_read_b32 v41, v40
    s_sub_u32 s17, s17, 1
    s_waitcnt lgkmcnt(0)
    v_readfirstlane_b32 s16, v41
    s_cmp_eq_u32 s17, 0
    s_cbranch_scc1 lwd_14
    s_cmp_ge_u32 s16, 1
    s_cbranch_scc1 lwd_14
    s_sleep 1
    s_branch lw_13
lwd_14:
    s_mov_b32 s15, s16
    s_waitcnt vmcnt(0)
    v_mov_b32 v40, 163364
    v_mov_b32 v41, 1
    v_mul_u32_u24 v42, 9472, v3
    v_mov_b32 v43, s15
    s_mov_b64 exec, 1
    ds_add_rtn_u32 v41, v40, v41
    s_waitcnt lgkmcnt(0)
    v_readfirstlane_b32 s16, v41
    s_mov_b64 exec, 0xff
    s_cmp_lg_u32 s16, 3
    s_cbranch_scc1 sig_15
    buffer_store_dword v43, v42, s[8:11], s26 offen sc1
sig_15:
    s_mov_b64 exec, -1
    s_setprio 0
    s_branch km_kernel_wpre
km_kernel_H:
    s_barrier
    s_cmp_lg_u32 s14, 10
    s_cbranch_scc1 nep_16
    s_mov_b32 s17, 32768
ep_17:
    buffer_load_dword v6, off, s[60:63], s48 sc1
    s_sub_u32 s17, s17, 1
    s_waitcnt vmcnt(0)
    v_readfirstlane_b32 s15, v6
    s_cmp_eq_u32 s17, 0
    s_cbranch_scc1 epd_18
    s_cmp_eq_u32 s15, 0
    s_cbranch_scc1 ep_17
epd_18:
    s_or_b32 s15, s15, 1
    v_mov_b32 v6, s15
    v_mov_b32 v7, 163328
    ds_write_b32 v7, v6
nep_16:
    v_mov_b32 v6, 163368
    s_mov_b32 s17, 262144
lw_19:
    ds_read_b32 v7, v6
    s_sub_u32 s17, s17, 1
    s_waitcnt lgkmcnt(0)
    v_readfirstlane_b32 s16, v7
    s_cmp_eq_u32 s17, 0
    s_cbranch_scc1 lwd_20
    s_cmp_ge_u32 s16, 1
    s_cbranch_scc1 lwd_20
    s_sleep 2
    s_branch lw_19
lwd_20:
km_kernel_H2:
    v_mul_u32_u24 v7, 4608, v3
    s_sub_u32 s30, s14, 8
    s_add_u32 s30, s30, s13
    s_and_b32 s30, s30, 3
    s_mul_i32 s16, s30, 589824
    s_lshl_b32 s17, s3, 3
    s_add_u32 s16, s16, s17
    buffer_load_dwordx2 v[44:45], v7, s[20:23], s16 offen offset:0
    buffer_load_dwordx2 v[46:47], v7, s[20:23], s16 offen offset:1152
    buffer_load_dwordx2 v[48:49], v7, s[20:23], s16 offen offset:2304
    buffer_load_dwordx2 v[50:51], v7, s[20:23], s16 offen offset:3456
    s_add_u32 s16, s16, 294912
    buffer_load_dwordx2 v[52:53], v7, s[20:23], s16 offen offset:0
    buffer_load_dwordx2 v[54:55], v7, s[20:23], s16 offen offset:1152
    buffer_load_dwordx2 v[56:57], v7, s[20:23], s16 offen offset:2304
    buffer_load_dwordx2 v[58:59], v7, s[20:23], s16 offen offset:3456
km_kernel_H3:
    v_lshlrev_b32 v90, 5, v3
    s_lshl_b32 s31, s30, 12
    s_add_u32 s31, s31, 19202048
    s_mov_b32 s28, 0x05040100
    s_mov_b32 s29, 0x07060302
    s_lshl_b32 s16, s30, 10
    v_lshl_add_u32 v6, v3, 3, s16
    v_mov_b32 v86, 0
    v_mov_b32 v87, 0
    s_mul_i32 s16, s30, 4608
    s_add_u32 s16, s16, 124032
    v_lshl_add_u32 v5, v3, 3, s16
    ds_write_b64 v5, v[86:87]
    v_add_u32 v4, 142464, v6
    s_waitcnt vmcnt(4)
    v_perm_b32 v60, v46, v44, s28
    v_perm_b32 v61, v50, v48, s28
    v_perm_b32 v62, v46, v44, s29
    v_perm_b32 v63, v50, v48, s29
    v_perm_b32 v64, v47, v45, s28
    v_perm_b32 v65, v51, v49, s28
    v_perm_b32 v66, v47, v45, s29
    v_perm_b32 v67, v51, v49, s29
    ds_write_b64 v4, v[60:61] offset:0
    ds_write_b64 v4, v[62:63] offset:4096
    ds_write_b64 v4, v[64:65] offset:8192
    ds_write_b64 v4, v[66:67] offset:12288
    s_waitcnt vmcnt(0)
    v_mov_b32 v88, 163452
    v_mov_b32 v89, 1
    s_mov_b64 exec, 1
    ds_add_u32 v88, v89
    s_mov_b64 exec, -1
    v_perm_b32 v68, v54, v52, s28
    v_perm_b32 v69, v58, v56, s28
    v_perm_b32 v70, v54, v52, s29
    v_perm_b32 v71, v58, v56, s29
    v_perm_b32 v72, v55, v53, s28
    v_perm_b32 v73, v59, v57, s28
    v_perm_b32 v74, v55, v53, s29
    v_perm_b32 v75, v59, v57, s29
    ds_write_b64 v4, v[68:69] offset:512
    ds_write_b64 v4, v[70:71] offset:4608
    ds_write_b64 v4, v[72:73] offset:8704
    ds_write_b64 v4, v[74:75] offset:12800
    v_mov_b32 v88, 163508
    v_mov_b32 v89, 1
    s_mov_b64 exec, 1
    ds_add_u32 v88, v89
    s_mov_b64 exec, -1
    v_add_u32 v4, 124544, v6
    v_mov_b32 v26, 163328
    s_mov_b32 s17, 262144
lw_24:
    ds_read_b32 v27, v26
    s_sub_u32 s17, s17, 1
    s_waitcnt lgkmcnt(0)
    v_readfirstlane_b32 s16, v27
    s_cmp_eq_u32 s17, 0
    s_cbranch_scc1 lwd_25
    s_cmp_ge_u32 s16, 1
    s_cbranch_scc1 lwd_25
    s_sleep 1
    s_branch lw_24
lwd_25:
    s_mov_b32 s15, s16
    v_mov_b32 v26, 163452
    s_mov_b32 s17, 262144
lw_26:
    ds_read_b32 v27, v26
    s_sub_u32 s17, s17, 1
    s_waitcnt lgkmcnt(0)
    v_readfirstlane_b32 s16, v27
    s_cmp_eq_u32 s17, 0
    s_cbranch_scc1 lwd_27
    s_cmp_ge_u32 s16, 4
    s_cbranch_scc1 lwd_27
    s_sleep 1
    s_branch lw_26
lwd_27:
    s_mov_b32 s17, 32768
gp_21:
    buffer_load_dwordx4 v[8:11], v90, s[8:11], s31 offen offset:0 sc1
    buffer_load_dwordx4 v[12:15], v90, s[8:11], s31 offen offset:16 sc1
    buffer_load_dwordx4 v[16:19], v90, s[8:11], s31 offen offset:2048 sc1
    buffer_load_dwordx4 v[20:23], v90, s[8:11], s31 offen offset:2064 sc1
gpc_23:
    s_sub_u32 s17, s17, 1
    s_cmp_eq_u32 s17, 0
    s_waitcnt vmcnt(0)
    s_cbranch_scc1 gpd_22
    v_xor_b32 v24, s15, v9
    v_xor_b32 v25, s15, v11
    v_or_b32 v24, v24, v25
    v_xor_b32 v25, s15, v13
    v_or_b32 v24, v24, v25
    v_xor_b32 v25, s15, v15
    v_or_b32 v24, v24, v25
    v_xor_b32 v25, s15, v17
    v_or_b32 v24, v24, v25
    v_xor_b32 v25, s15, v19
    v_or_b32 v24, v24, v25
    v_xor_b32 v25, s15, v21
    v_or_b32 v24, v24, v25
    v_xor_b32 v25, s15, v23
    v_or_b32 v24, v24, v25
    v_cmp_ne_u32 vcc, 0, v24
    s_nop 4
    s_cbranch_vccnz gp_21
gpd_22:
    v_mov_b32 v26, 163504
    v_mov_b32 v27, 1
    s_mov_b64 exec, 1
    ds_add_u32 v26, v27
    s_mov_b64 exec, -1
    v_lshlrev_b32 v9, 16, v8
    v_and_b32 v8, 0xffff0000, v8
    v_rcp_f32 v8, v8
    v_lshlrev_b32 v11, 16, v10
    v_and_b32 v10, 0xffff0000, v10
    v_rcp_f32 v10, v10
    v_lshlrev_b32 v13, 16, v12
    v_and_b32 v12, 0xffff0000, v12
    v_rcp_f32 v12, v12
    v_lshlrev_b32 v15, 16, v14
    v_and_b32 v14, 0xffff0000, v14
    v_rcp_f32 v14, v14
    v_lshlrev_b32 v17, 16, v16
    v_and_b32 v16, 0xffff0000, v16
    v_rcp_f32 v16, v16
    v_lshlrev_b32 v19, 16, v18
    v_and_b32 v18, 0xffff0000, v18
    v_rcp_f32 v18, v18
    v_lshlrev_b32 v21, 16, v20
    v_and_b32 v20, 0xffff0000, v20
    v_rcp_f32 v20, v20
    v_lshlrev_b32 v23, 16, v22
    v_and_b32 v22, 0xffff0000, v22
    v_rcp_f32 v22, v22
    s_nop 0
    v_mul_f32 v9, -v9, v8
    v_mul_f32 v11, -v11, v10
    v_mul_f32 v13, -v13, v12
    v_mul_f32 v15, -v15, v14
    v_mul_f32 v17, -v17, v16
    v_mul_f32 v19, -v19, v18
    v_mul_f32 v21, -v21, v20
    v_mul_f32 v23, -v23, v22
    v_lshlrev_b32 v28, 16, v60
    v_and_b32 v29, 0xffff0000, v60
    v_fma_f32 v28, v28, v8, v9
    v_fma_f32 v29, v29, v10, v11
    v_cvt_pk_bf16_f32 v60, v28, v29
    v_lshlrev_b32 v30, 16, v61
    v_and_b32 v31, 0xffff0000, v61
    v_fma_f32 v30, v30, v12, v13
    v_fma_f32 v31, v31, v14, v15
    v_cvt_pk_bf16_f32 v61, v30, v31
    ds_write_b64 v4, v[60:61] offset:0
    v_lshlrev_b32 v32, 16, v62
    v_and_b32 v33, 0xffff0000, v62
    v_fma_f32 v32, v32, v8, v9
    v_fma_f32 v33, v33, v10, v11
    v_cvt_pk_bf16_f32 v62, v32, v33
    v_lshlrev_b32 v34, 16, v63
    v_and_b32 v35, 0xffff0000, v63
    v_fma_f32 v34, v34, v12, v13
    v_fma_f32 v35, v35, v14, v15
    v_cvt_pk_bf16_f32 v63, v34, v35
    ds_write_b64 v4, v[62:63] offset:4608
    v_lshlrev_b32 v28, 16, v64
    v_and_b32 v29, 0xffff0000, v64
    v_fma_f32 v28, v28, v8, v9
    v_fma_f32 v29, v29, v10, v11
    v_cvt_pk_bf16_f32 v64, v28, v29
    v_lshlrev_b32 v30, 16, v65
    v_and_b32 v31, 0xffff0000, v65
    v_fma_f32 v30, v30, v12, v13
    v_fma_f32 v31, v31, v14, v15
    v_cvt_pk_bf16_f32 v65, v30, v31
    ds_write_b64 v4, v[64:65] offset:9216
    v_lshlrev_b32 v32, 16, v66
    v_and_b32 v33, 0xffff0000, v66
    v_fma_f32 v32, v32, v8, v9
    v_fma_f32 v33, v33, v10, v11
    v_cvt_pk_bf16_f32 v66, v32, v33
    v_lshlrev_b32 v34, 16, v67
    v_and_b32 v35, 0xffff0000, v67
    v_fma_f32 v34, v34, v12, v13
    v_fma_f32 v35, v35, v14, v15
    v_cvt_pk_bf16_f32 v67, v34, v35
    ds_write_b64 v4, v[66:67] offset:13824
    v_lshlrev_b32 v28, 16, v68
    v_and_b32 v29, 0xffff0000, v68
    v_fma_f32 v28, v28, v16, v17
    v_fma_f32 v29, v29, v18, v19
    v_cvt_pk_bf16_f32 v68, v28, v29
    v_lshlrev_b32 v30, 16, v69
    v_and_b32 v31, 0xffff0000, v69
    v_fma_f32 v30, v30, v20, v21
    v_fma_f32 v31, v31, v22, v23
    v_cvt_pk_bf16_f32 v69, v30, v31
    ds_write_b64 v4, v[68:69] offset:512
    v_lshlrev_b32 v32, 16, v70
    v_and_b32 v33, 0xffff0000, v70
    v_fma_f32 v32, v32, v16, v17
    v_fma_f32 v33, v33, v18, v19
    v_cvt_pk_bf16_f32 v70, v32, v33
    v_lshlrev_b32 v34, 16, v71
    v_and_b32 v35, 0xffff0000, v71
    v_fma_f32 v34, v34, v20, v21
    v_fma_f32 v35, v35, v22, v23
    v_cvt_pk_bf16_f32 v71, v34, v35
    ds_write_b64 v4, v[70:71] offset:5120
    v_lshlrev_b32 v28, 16, v72
    v_and_b32 v29, 0xffff0000, v72
    v_fma_f32 v28, v28, v16, v17
    v_fma_f32 v29, v29, v18, v19
    v_cvt_pk_bf16_f32 v72, v28, v29
    v_lshlrev_b32 v30, 16, v73
    v_and_b32 v31, 0xffff0000, v73
    v_fma_f32 v30, v30, v20, v21
    v_fma_f32 v31, v31, v22, v23
    v_cvt_pk_bf16_f32 v73, v30, v31
    ds_write_b64 v4, v[72:73] offset:9728
    v_lshlrev_b32 v32, 16, v74
    v_and_b32 v33, 0xffff0000, v74
    v_fma_f32 v32, v32, v16, v17
    v_fma_f32 v33, v33, v18, v19
    v_cvt_pk_bf16_f32 v74, v32, v33
    v_lshlrev_b32 v34, 16, v75
    v_and_b32 v35, 0xffff0000, v75
    v_fma_f32 v34, v34, v20, v21
    v_fma_f32 v35, v35, v22, v23
    v_cvt_pk_bf16_f32 v75, v34, v35
    ds_write_b64 v4, v[74:75] offset:14336
    v_mov_b32 v36, 163360
    v_mov_b32 v37, 1
    s_mov_b64 exec, 1
    ds_add_u32 v36, v37
    s_mov_b64 exec, -1
    s_branch km_kernel_wpre
km_kernel_PW:
    s_load_dwordx8 s[52:59], s[0:1], 80
    s_waitcnt lgkmcnt(0)
    s_sub_u32 s46, s13, 18
    s_mov_b32 s47, 5
    s_mov_b32 s49, 4
    s_cmp_ge_u32 s14, 6
    s_cbranch_scc1 km_kernel_pw_idle
    s_cmp_ge_u32 s14, 4
    s_cbranch_scc1 km_kernel_pw12
    s_cmp_lg_u32 s14, 0
    s_cbranch_scc1 nz_28
    v_mov_b32 v28, 0
    v_lshlrev_b32 v29, 2, v3
    v_add_u32 v29, 163328, v29
    ds_write_b32 v29, v28
    s_waitcnt lgkmcnt(0)
nz_28:
    s_barrier
    s_lshl_b32 s16, s46, 2
    s_add_u32 s16, s16, s14
    s_mul_i32 s42, s12, 54
    s_add_u32 s42, s42, s16
    s_add_u32 s42, s42, 162
    s_add_u32 s36, s12, 2
    s_add_u32 s17, s12, 10
    s_sub_u32 s18, s16, 27
    s_cmp_ge_u32 s16, 27
    s_cselect_b32 s36, s17, s36
    s_cselect_b32 s17, s18, s16
    s_mul_i32 s38, s17, 57
    s_lshr_b32 s38, s38, 9
    s_mul_i32 s37, s38, 9
    s_sub_u32 s37, s17, s37
    s_mul_i32 s43, s14, 24576
    s_cmp_lt_u32 s16, 54
    s_cbranch_scc1 km_kernel_pk3
    v_mov_b32 v28, 163384
    v_mov_b32 v29, 1
    s_mov_b64 exec, 1
    ds_add_u32 v28, v29
    s_mov_b64 exec, -1
    s_branch km_kernel_wpre
km_kernel_pk3:
    s_mov_b32 s20, 1152
    s_mul_i32 s21, s12, 1152
    s_mul_i32 s22, s12, 663552
    s_cmp_ge_u32 s36, 10
    s_cselect_b32 s20, s20, 9216
    s_cselect_b32 s21, s22, s21
    v_lshrrev_b32 v4, 3, v3
    v_mul_lo_u32 v5, v4, s20
    v_and_b32 v6, 7, v3
    v_and_b32 v7, 2, v4
    v_xor_b32 v6, v6, v7
    v_lshl_add_u32 v4, v6, 4, v5
    v_xor_b32 v6, 4, v6
    v_lshl_add_u32 v5, v6, 4, v5
    s_mul_i32 s22, s38, 192
    s_mul_i32 s22, s22, s20
    s_add_u32 s21, s21, s22
    s_lshl_b32 s22, s37, 7
    s_add_u32 s21, s21, s22
    s_lshl_b32 s22, s20, 3
    s_mov_b32 s23, s43
    s_cmp_ge_u32 s36, 10
    s_waitcnt lgkmcnt(0)
    s_cselect_b64 s[32:33], s[58:59], s[56:57]
    s_and_b32 s33, s33, 0xffff
    s_mov_b32 s34, 5308416
    s_mov_b32 s35, 0x20000
    v_mov_b32 v6, 163368
    s_mov_b32 s17, 262144
lw_29:
    ds_read_b32 v7, v6
    s_sub_u32 s17, s17, 1
    s_waitcnt lgkmcnt(0)
    v_readfirstlane_b32 s16, v7
    s_cmp_eq_u32 s17, 0
    s_cbranch_scc1 lwd_30
    s_cmp_ge_u32 s16, s47
    s_cbranch_scc1 lwd_30
    s_sleep 4
    s_branch lw_29
lwd_30:
    s_mov_b32 s39, 12
pk_31:
    s_mov_b32 m0, s23
    s_add_u32 s23, s23, 1024
    buffer_load_dwordx4 v4, s[32:35], s21 offen nt lds
    s_add_u32 s21, s21, s22
    s_mov_b32 m0, s23
    s_add_u32 s23, s23, 1024
    buffer_load_dwordx4 v5, s[32:35], s21 offen nt lds
    s_add_u32 s21, s21, s22
    s_sub_u32 s39, s39, 1
    s_cmp_lg_u32 s39, 0
    s_cbranch_scc1 pk_31
    v_lshrrev_b32 v8, 4, v3
    v_bfe_u32 v9, v3, 2, 2
    v_lshl_add_u32 v10, v8, 3, v9
    v_lshlrev_b32 v10, 7, v10
    v_and_b32 v11, 3, v3
    v_lshl_add_u32 v10, v11, 3, v10
    v_bfe_u32 v11, v3, 3, 2
    v_lshl_add_u32 v10, v11, 5, v10
    v_add_u32 v4, s43, v10
    v_xor_b32 v5, 32, v4
    v_xor_b32 v6, 64, v4
    v_xor_b32 v7, 96, v4
    s_mul_i32 s21, s36, 663552
    s_mul_i32 s22, s38, 18432
    s_add_u32 s21, s21, s22
    s_add_u32 s21, s21, 19922944
    s_lshl_b32 s16, s37, 2
    s_mul_i32 s17, s16, 43
    s_lshr_b32 s17, s17, 7
    s_mul_i32 s17, s17, 51
    s_add_u32 s17, s17, s16
    s_lshl_b32 s17, s17, 10
    s_add_u32 s24, s17, s21
    s_lshl_b32 s16, s37, 2
    s_add_u32 s16, s16, 1
    s_mul_i32 s17, s16, 43
    s_lshr_b32 s17, s17, 7
    s_mul_i32 s17, s17, 51
    s_add_u32 s17, s17, s16
    s_lshl_b32 s17, s17, 10
    s_add_u32 s25, s17, s21
    s_lshl_b32 s16, s37, 2
    s_add_u32 s16, s16, 2
    s_mul_i32 s17, s16, 43
    s_lshr_b32 s17, s17, 7
    s_mul_i32 s17, s17, 51
    s_add_u32 s17, s17, s16
    s_lshl_b32 s17, s17, 10
    s_add_u32 s26, s17, s21
    s_lshl_b32 s16, s37, 2
    s_add_u32 s16, s16, 3
    s_mul_i32 s17, s16, 43
    s_lshr_b32 s17, s17, 7
    s_mul_i32 s17, s17, 51
    s_add_u32 s17, s17, s16
    s_lshl_b32 s17, s17, 10
    s_add_u32 s27, s17, s21
    v_mov_b32 v8, 0x3f803f80
    v_mov_b32 v9, 0x3f803f80
    v_mov_b32 v10, 0x3f803f80
    v_mov_b32 v11, 0x3f803f80
    v_mov_b32 v12, 0
    v_mov_b32 v13, 0
    v_mov_b32 v14, 0
    v_mov_b32 v15, 0
    v_mov_b32 v16, 0
    v_mov_b32 v17, 0
    v_mov_b32 v18, 0
    v_mov_b32 v19, 0
    v_mov_b32 v20, 0
    v_mov_b32 v21, 0
    v_mov_b32 v22, 0
    v_mov_b32 v23, 0
    v_mov_b32 v24, 0
    v_mov_b32 v25, 0
    v_mov_b32 v26, 0
    v_mov_b32 v27, 0
    s_waitcnt vmcnt(0)
    ds_read_b64_tr_b16 v[28:29], v4 offset:0
    ds_read_b64_tr_b16 v[30:31], v4 offset:512
    ds_read_b64_tr_b16 v[32:33], v5 offset:0
    ds_read_b64_tr_b16 v[34:35], v5 offset:512
    ds_read_b64_tr_b16 v[36:37], v6 offset:0
    ds_read_b64_tr_b16 v[38:39], v6 offset:512
    ds_read_b64_tr_b16 v[40:41], v7 offset:0
    ds_read_b64_tr_b16 v[42:43], v7 offset:512
    ds_read_b64_tr_b16 v[44:45], v4 offset:4096
    ds_read_b64_tr_b16 v[46:47], v4 offset:4608
    ds_read_b64_tr_b16 v[48:49], v5 offset:4096
    ds_read_b64_tr_b16 v[50:51], v5 offset:4608
    ds_read_b64_tr_b16 v[52:53], v6 offset:4096
    ds_read_b64_tr_b16 v[54:55], v6 offset:4608
    ds_read_b64_tr_b16 v[56:57], v7 offset:4096
    ds_read_b64_tr_b16 v[58:59], v7 offset:4608
    s_waitcnt lgkmcnt(8)
    buffer_store_dwordx4 v[28:31], v1, s[8:11], s24 offen offset:0 sc1
    v_mfma_f32_16x16x32_bf16 v[12:15], v[28:31], v[8:11], v[12:15]
    buffer_store_dwordx4 v[32:35], v1, s[8:11], s25 offen offset:0 sc1
    v_mfma_f32_16x16x32_bf16 v[16:19], v[32:35], v[8:11], v[16:19]
    buffer_store_dwordx4 v[36:39], v1, s[8:11], s26 offen offset:0 sc1
    v_mfma_f32_16x16x32_bf16 v[20:23], v[36:39], v[8:11], v[20:23]
    buffer_store_dwordx4 v[40:43], v1, s[8:11], s27 offen offset:0 sc1
    v_mfma_f32_16x16x32_bf16 v[24:27], v[40:43], v[8:11], v[24:27]
    s_waitcnt lgkmcnt(0)
    buffer_store_dwordx4 v[44:47], v1, s[8:11], s24 offen offset:3072 sc1
    v_mfma_f32_16x16x32_bf16 v[12:15], v[44:47], v[8:11], v[12:15]
    buffer_store_dwordx4 v[48:51], v1, s[8:11], s25 offen offset:3072 sc1
    v_mfma_f32_16x16x32_bf16 v[16:19], v[48:51], v[8:11], v[16:19]
    buffer_store_dwordx4 v[52:55], v1, s[8:11], s26 offen offset:3072 sc1
    v_mfma_f32_16x16x32_bf16 v[20:23], v[52:55], v[8:11], v[20:23]
    buffer_store_dwordx4 v[56:59], v1, s[8:11], s27 offen offset:3072 sc1
    v_mfma_f32_16x16x32_bf16 v[24:27], v[56:59], v[8:11], v[24:27]
    s_add_u32 s24, s24, 6144
    s_add_u32 s25, s25, 6144
    s_add_u32 s26, s26, 6144
    s_add_u32 s27, s27, 6144
    s_waitcnt vmcnt(16)
    ds_read_b64_tr_b16 v[60:61], v4 offset:8192
    ds_read_b64_tr_b16 v[62:63], v4 offset:8704
    ds_read_b64_tr_b16 v[64:65], v5 offset:8192
    ds_read_b64_tr_b16 v[66:67], v5 offset:8704
    ds_read_b64_tr_b16 v[68:69], v6 offset:8192
    ds_read_b64_tr_b16 v[70:71], v6 offset:8704
    ds_read_b64_tr_b16 v[72:73], v7 offset:8192
    ds_read_b64_tr_b16 v[74:75], v7 offset:8704
    ds_read_b64_tr_b16 v[76:77], v4 offset:12288
    ds_read_b64_tr_b16 v[78:79], v4 offset:12800
    ds_read_b64_tr_b16 v[80:81], v5 offset:12288
    ds_read_b64_tr_b16 v[82:83], v5 offset:12800
    ds_read_b64_tr_b16 v[84:85], v6 offset:12288
    ds_read_b64_tr_b16 v[86:87], v6 offset:12800
    ds_read_b64_tr_b16 v[88:89], v7 offset:12288
    ds_read_b64_tr_b16 v[90:91], v7 offset:12800
    s_waitcnt lgkmcnt(8)
    buffer_store_dwordx4 v[60:63], v1, s[8:11], s24 offen offset:0 sc1
    v_mfma_f32_16x16x32_bf16 v[12:15], v[60:63], v[8:11], v[12:15]
    buffer_store_dwordx4 v[64:67], v1, s[8:11], s25 offen offset:0 sc1
    v_mfma_f32_16x16x32_bf16 v[16:19], v[64:67], v[8:11], v[16:19]
    buffer_store_dwordx4 v[68:71], v1, s[8:11], s26 offen offset:0 sc1
    v_mfma_f32_16x16x32_bf16 v[20:23], v[68:71], v[8:11], v[20:23]
    buffer_store_dwordx4 v[72:75], v1, s[8:11], s27 offen offset:0 sc1
    v_mfma_f32_16x16x32_bf16 v[24:27], v[72:75], v[8:11], v[24:27]
    s_waitcnt lgkmcnt(0)
    buffer_store_dwordx4 v[76:79], v1, s[8:11], s24 offen offset:3072 sc1
    v_mfma_f32_16x16x32_bf16 v[12:15], v[76:79], v[8:11], v[12:15]
    buffer_store_dwordx4 v[80:83], v1, s[8:11], s25 offen offset:3072 sc1
    v_mfma_f32_16x16x32_bf16 v[16:19], v[80:83], v[8:11], v[16:19]
    buffer_store_dwordx4 v[84:87], v1, s[8:11], s26 offen offset:3072 sc1
    v_mfma_f32_16x16x32_bf16 v[20:23], v[84:87], v[8:11], v[20:23]
    buffer_store_dwordx4 v[88:91], v1, s[8:11], s27 offen offset:3072 sc1
    v_mfma_f32_16x16x32_bf16 v[24:27], v[88:91], v[8:11], v[24:27]
    s_add_u32 s24, s24, 6144
    s_add_u32 s25, s25, 6144
    s_add_u32 s26, s26, 6144
    s_add_u32 s27, s27, 6144
    s_waitcnt vmcnt(16)
    v_mov_b32 v100, 163384
    v_mov_b32 v101, 1
    s_mov_b64 exec, 1
    ds_add_u32 v100, v101
    s_mov_b64 exec, -1
    ds_read_b64_tr_b16 v[28:29], v4 offset:16384
    ds_read_b64_tr_b16 v[30:31], v4 offset:16896
    ds_read_b64_tr_b16 v[32:33], v5 offset:16384
    ds_read_b64_tr_b16 v[34:35], v5 offset:16896
    ds_read_b64_tr_b16 v[36:37], v6 offset:16384
    ds_read_b64_tr_b16 v[38:39], v6 offset:16896
    ds_read_b64_tr_b16 v[40:41], v7 offset:16384
    ds_read_b64_tr_b16 v[42:43], v7 offset:16896
    ds_read_b64_tr_b16 v[44:45], v4 offset:20480
    ds_read_b64_tr_b16 v[46:47], v4 offset:20992
    ds_read_b64_tr_b16 v[48:49], v5 offset:20480
    ds_read_b64_tr_b16 v[50:51], v5 offset:20992
    ds_read_b64_tr_b16 v[52:53], v6 offset:20480
    ds_read_b64_tr_b16 v[54:55], v6 offset:20992
    ds_read_b64_tr_b16 v[56:57], v7 offset:20480
    ds_read_b64_tr_b16 v[58:59], v7 offset:20992
    s_waitcnt lgkmcnt(8)
    buffer_store_dwordx4 v[28:31], v1, s[8:11], s24 offen offset:0 sc1
    v_mfma_f32_16x16x32_bf16 v[12:15], v[28:31], v[8:11], v[12:15]
    buffer_store_dwordx4 v[32:35], v1, s[8:11], s25 offen offset:0 sc1
    v_mfma_f32_16x16x32_bf16 v[16:19], v[32:35], v[8:11], v[16:19]
    buffer_store_dwordx4 v[36:39], v1, s[8:11], s26 offen offset:0 sc1
    v_mfma_f32_16x16x32_bf16 v[20:23], v[36:39], v[8:11], v[20:23]
    buffer_store_dwordx4 v[40:43], v1, s[8:11], s27 offen offset:0 sc1
    v_mfma_f32_16x16x32_bf16 v[24:27], v[40:43], v[8:11], v[24:27]
    s_waitcnt lgkmcnt(0)
    buffer_store_dwordx4 v[44:47], v1, s[8:11], s24 offen offset:3072 sc1
    v_mfma_f32_16x16x32_bf16 v[12:15], v[44:47], v[8:11], v[12:15]
    buffer_store_dwordx4 v[48:51], v1, s[8:11], s25 offen offset:3072 sc1
    v_mfma_f32_16x16x32_bf16 v[16:19], v[48:51], v[8:11], v[16:19]
    buffer_store_dwordx4 v[52:55], v1, s[8:11], s26 offen offset:3072 sc1
    v_mfma_f32_16x16x32_bf16 v[20:23], v[52:55], v[8:11], v[20:23]
    buffer_store_dwordx4 v[56:59], v1, s[8:11], s27 offen offset:3072 sc1
    v_mfma_f32_16x16x32_bf16 v[24:27], v[56:59], v[8:11], v[24:27]
    s_cmp_ge_u32 s36, 10
    s_cbranch_scc1 nocs_32
    s_mul_i32 s16, s38, 18432
    s_mul_i32 s17, s12, 2304
    s_add_u32 s16, s16, s17
    s_add_u32 s23, s16, 19087360
    s_lshl_b32 s22, s37, 8
    s_add_u32 s23, s23, s22
    v_and_b32 v5, 15, v3
    v_cmp_eq_u32 vcc, 0, v5
    v_and_b32 v5, 48, v3
    s_and_saveexec_b64 s[40:41], vcc
    buffer_store_dwordx4 v[12:15], v5, s[8:11], s23 offen offset:0 sc1
    buffer_store_dwordx4 v[16:19], v5, s[8:11], s23 offen offset:64 sc1
    buffer_store_dwordx4 v[20:23], v5, s[8:11], s23 offen offset:128 sc1
    buffer_store_dwordx4 v[24:27], v5, s[8:11], s23 offen offset:192 sc1
    s_mov_b64 exec, -1
nocs_32:
    v_mov_b32 v6, 163328
    s_mov_b32 s17, 262144
lw_33:
    ds_read_b32 v7, v6
    s_sub_u32 s17, s17, 1
    s_waitcnt lgkmcnt(0)
    v_readfirstlane_b32 s16, v7
    s_cmp_eq_u32 s17, 0
    s_cbranch_scc1 lwd_34
    s_cmp_ge_u32 s16, 1
    s_cbranch_scc1 lwd_34
    s_sleep 1
    s_branch lw_33
lwd_34:
    s_mov_b32 s15, s16
    s_lshl_b32 s26, s42, 7
    s_add_u32 s26, s26, 19464192
    v_mov_b32 v6, s15
    s_waitcnt vmcnt(0)
    s_mov_b64 exec, 1
    buffer_store_dword v6, off, s[8:11], s26 sc1
    s_mov_b64 exec, -1
    s_branch km_kernel_wpre
km_kernel_pw12:
    s_sub_u32 s16, s14, 4
    s_mul_i32 s16, s16, 112
    s_mul_i32 s17, s12, 14
    s_add_u32 s16, s16, s17
    s_add_u32 s42, s16, s46
    s_sub_u32 s17, s42, 81
    s_cmp_ge_u32 s42, 81
    s_cselect_b32 s36, 1, 0
    s_cselect_b32 s17, s17, s42
    s_mul_i32 s37, s17, 57
    s_lshr_b32 s37, s37, 9
    s_mul_i32 s38, s37, 9
    s_sub_u32 s38, s17, s38
    s_lshl_b32 s43, s14, 13
    s_add_u32 s43, s43, 65536
    s_cmp_lt_u32 s42, 162
    s_cbranch_scc1 km_kernel_pk1
    s_barrier
    v_mov_b32 v28, 163368
    v_mov_b32 v29, 1
    s_mov_b64 exec, 1
    ds_add_u32 v28, v29
    s_mov_b64 exec, -1
    s_branch km_kernel_wpre
km_kernel_pk1:
    s_mov_b32 s20, 1152
    s_mov_b32 s21, 0
    v_lshrrev_b32 v4, 3, v3
    v_mul_lo_u32 v5, v4, s20
    v_and_b32 v6, 7, v3
    v_and_b32 v7, 2, v4
    v_xor_b32 v6, v6, v7
    v_lshl_add_u32 v4, v6, 4, v5
    v_xor_b32 v6, 4, v6
    v_lshl_add_u32 v5, v6, 4, v5
    s_mul_i32 s22, s38, 64
    s_mul_i32 s22, s22, s20
    s_add_u32 s21, s21, s22
    s_lshl_b32 s22, s37, 7
    s_add_u32 s21, s21, s22
    s_lshl_b32 s22, s20, 3
    s_mov_b32 s23, s43
    s_cmp_ge_u32 s36, 1
    s_waitcnt lgkmcnt(0)
    s_cselect_b64 s[32:33], s[54:55], s[52:53]
    s_and_b32 s33, s33, 0xffff
    s_mov_b32 s34, 663552
    s_mov_b32 s35, 0x20000
    s_mov_b32 s39, 4
pk_35:
    s_mov_b32 m0, s23
    s_add_u32 s23, s23, 1024
    buffer_load_dwordx4 v4, s[32:35], s21 offen nt lds
    s_add_u32 s21, s21, s22
    s_mov_b32 m0, s23
    s_add_u32 s23, s23, 1024
    buffer_load_dwordx4 v5, s[32:35], s21 offen nt lds
    s_add_u32 s21, s21, s22
    s_sub_u32 s39, s39, 1
    s_cmp_lg_u32 s39, 0
    s_cbranch_scc1 pk_35
    s_barrier
    v_lshrrev_b32 v8, 4, v3
    v_bfe_u32 v9, v3, 2, 2
    v_lshl_add_u32 v10, v8, 3, v9
    v_lshlrev_b32 v10, 7, v10
    v_and_b32 v11, 3, v3
    v_lshl_add_u32 v10, v11, 3, v10
    v_bfe_u32 v11, v3, 3, 2
    v_lshl_add_u32 v10, v11, 5, v10
    v_add_u32 v4, s43, v10
    v_xor_b32 v5, 32, v4
    v_xor_b32 v6, 64, v4
    v_xor_b32 v7, 96, v4
    s_mul_i32 s21, s36, 663552
    s_mul_i32 s22, s38, 6144
    s_add_u32 s21, s21, s22
    s_add_u32 s21, s21, 19922944
    s_lshl_b32 s16, s37, 2
    s_mul_i32 s17, s16, 43
    s_lshr_b32 s17, s17, 7
    s_mul_i32 s17, s17, 51
    s_add_u32 s17, s17, s16
    s_lshl_b32 s17, s17, 10
    s_add_u32 s24, s17, s21
    s_lshl_b32 s16, s37, 2
    s_add_u32 s16, s16, 1
    s_mul_i32 s17, s16, 43
    s_lshr_b32 s17, s17, 7
    s_mul_i32 s17, s17, 51
    s_add_u32 s17, s17, s16
    s_lshl_b32 s17, s17, 10
    s_add_u32 s25, s17, s21
    s_lshl_b32 s16, s37, 2
    s_add_u32 s16, s16, 2
    s_mul_i32 s17, s16, 43
    s_lshr_b32 s17, s17, 7
    s_mul_i32 s17, s17, 51
    s_add_u32 s17, s17, s16
    s_lshl_b32 s17, s17, 10
    s_add_u32 s26, s17, s21
    s_lshl_b32 s16, s37, 2
    s_add_u32 s16, s16, 3
    s_mul_i32 s17, s16, 43
    s_lshr_b32 s17, s17, 7
    s_mul_i32 s17, s17, 51
    s_add_u32 s17, s17, s16
    s_lshl_b32 s17, s17, 10
    s_add_u32 s27, s17, s21
    s_waitcnt vmcnt(0)
    ds_read_b64_tr_b16 v[28:29], v4 offset:0
    ds_read_b64_tr_b16 v[30:31], v4 offset:512
    ds_read_b64_tr_b16 v[32:33], v5 offset:0
    ds_read_b64_tr_b16 v[34:35], v5 offset:512
    ds_read_b64_tr_b16 v[36:37], v6 offset:0
    ds_read_b64_tr_b16 v[38:39], v6 offset:512
    ds_read_b64_tr_b16 v[40:41], v7 offset:0
    ds_read_b64_tr_b16 v[42:43], v7 offset:512
    ds_read_b64_tr_b16 v[44:45], v4 offset:4096
    ds_read_b64_tr_b16 v[46:47], v4 offset:4608
    ds_read_b64_tr_b16 v[48:49], v5 offset:4096
    ds_read_b64_tr_b16 v[50:51], v5 offset:4608
    ds_read_b64_tr_b16 v[52:53], v6 offset:4096
    ds_read_b64_tr_b16 v[54:55], v6 offset:4608
    ds_read_b64_tr_b16 v[56:57], v7 offset:4096
    ds_read_b64_tr_b16 v[58:59], v7 offset:4608
    s_waitcnt lgkmcnt(8)
    buffer_store_dwordx4 v[28:31], v1, s[8:11], s24 offen offset:0 sc1
    buffer_store_dwordx4 v[32:35], v1, s[8:11], s25 offen offset:0 sc1
    buffer_store_dwordx4 v[36:39], v1, s[8:11], s26 offen offset:0 sc1
    buffer_store_dwordx4 v[40:43], v1, s[8:11], s27 offen offset:0 sc1
    s_waitcnt lgkmcnt(0)
    buffer_store_dwordx4 v[44:47], v1, s[8:11], s24 offen offset:3072 sc1
    buffer_store_dwordx4 v[48:51], v1, s[8:11], s25 offen offset:3072 sc1
    buffer_store_dwordx4 v[52:55], v1, s[8:11], s26 offen offset:3072 sc1
    buffer_store_dwordx4 v[56:59], v1, s[8:11], s27 offen offset:3072 sc1
    v_mov_b32 v6, 163328
    s_mov_b32 s17, 262144
lw_36:
    ds_read_b32 v7, v6
    s_sub_u32 s17, s17, 1
    s_waitcnt lgkmcnt(0)
    v_readfirstlane_b32 s16, v7
    s_cmp_eq_u32 s17, 0
    s_cbranch_scc1 lwd_37
    s_cmp_ge_u32 s16, 1
    s_cbranch_scc1 lwd_37
    s_sleep 1
    s_branch lw_36
lwd_37:
    s_mov_b32 s15, s16
    s_lshl_b32 s26, s42, 7
    s_add_u32 s26, s26, 19464192
    v_mov_b32 v6, s15
    s_waitcnt vmcnt(0)
    s_mov_b64 exec, 1
    buffer_store_dword v6, off, s[8:11], s26 sc1
    s_mov_b64 exec, -1
    s_waitcnt vmcnt(0)
    v_mov_b32 v6, 163368
    v_mov_b32 v7, 1
    s_mov_b64 exec, 1
    ds_add_u32 v6, v7
    s_mov_b64 exec, -1
    s_branch km_kernel_wpre
km_kernel_pw_idle:
    s_sub_u32 s30, s14, 7
    s_cmp_lt_u32 s30, 3
    s_cbranch_scc1 km_kernel_ST
    s_barrier
    s_cmp_lg_u32 s14, 10
    s_cbranch_scc1 km_kernel_wpre
    s_mov_b32 s17, 32768
ep_38:
    buffer_load_dword v6, off, s[60:63], s48 sc1
    s_sub_u32 s17, s17, 1
    s_waitcnt vmcnt(0)
    v_readfirstlane_b32 s15, v6
    s_cmp_eq_u32 s17, 0
    s_cbranch_scc1 epd_39
    s_cmp_eq_u32 s15, 0
    s_cbranch_scc1 ep_38
epd_39:
    s_or_b32 s15, s15, 1
    v_mov_b32 v6, s15
    v_mov_b32 v7, 163328
    ds_write_b32 v7, v6
    s_branch km_kernel_wpre
km_kernel_ST:
    v_lshrrev_b32 v4, 3, v3
    v_and_b32 v5, 7, v3
    v_mul_u32_u24 v6, 1152, v4
    v_lshl_add_u32 v6, v5, 4, v6
    s_mul_i32 s30, s30, 112
    s_mul_i32 s16, s46, 8
    s_add_u32 s30, s30, s16
    s_add_u32 s30, s30, s12
    s_mul_i32 s16, s30, 9216
    buffer_load_dwordx4 v[8:11], v6, s[20:23], s16 offen offset:0
    buffer_load_dwordx4 v[12:15], v6, s[20:23], s16 offen offset:128
    buffer_load_dwordx4 v[16:19], v6, s[20:23], s16 offen offset:256
    buffer_load_dwordx4 v[20:23], v6, s[20:23], s16 offen offset:384
    buffer_load_dwordx4 v[24:27], v6, s[20:23], s16 offen offset:512
    buffer_load_dwordx4 v[28:31], v6, s[20:23], s16 offen offset:640
    buffer_load_dwordx4 v[32:35], v6, s[20:23], s16 offen offset:768
    buffer_load_dwordx4 v[36:39], v6, s[20:23], s16 offen offset:896
    buffer_load_dwordx4 v[40:43], v6, s[20:23], s16 offen offset:1024
    s_barrier
    v_mov_b32 v80, 0x3f803f80
    v_mov_b32 v76, 0
    v_mov_b32 v78, 0
    v_mov_b32 v77, 0
    v_mov_b32 v79, 0
    s_setprio 3
    s_waitcnt vmcnt(0)
    v_dot2_f32_bf16 v76, v8, v80, v76
    v_dot2_f32_bf16 v78, v8, v8, v78
    v_dot2_f32_bf16 v77, v9, v80, v77
    v_dot2_f32_bf16 v79, v9, v9, v79
    v_dot2_f32_bf16 v76, v10, v80, v76
    v_dot2_f32_bf16 v78, v10, v10, v78
    v_dot2_f32_bf16 v77, v11, v80, v77
    v_dot2_f32_bf16 v79, v11, v11, v79
    v_dot2_f32_bf16 v76, v12, v80, v76
    v_dot2_f32_bf16 v78, v12, v12, v78
    v_dot2_f32_bf16 v77, v13, v80, v77
    v_dot2_f32_bf16 v79, v13, v13, v79
    v_dot2_f32_bf16 v76, v14, v80, v76
    v_dot2_f32_bf16 v78, v14, v14, v78
    v_dot2_f32_bf16 v77, v15, v80, v77
    v_dot2_f32_bf16 v79, v15, v15, v79
    v_dot2_f32_bf16 v76, v16, v80, v76
    v_dot2_f32_bf16 v78, v16, v16, v78
    v_dot2_f32_bf16 v77, v17, v80, v77
    v_dot2_f32_bf16 v79, v17, v17, v79
    v_dot2_f32_bf16 v76, v18, v80, v76
    v_dot2_f32_bf16 v78, v18, v18, v78
    v_dot2_f32_bf16 v77, v19, v80, v77
    v_dot2_f32_bf16 v79, v19, v19, v79
    v_dot2_f32_bf16 v76, v20, v80, v76
    v_dot2_f32_bf16 v78, v20, v20, v78
    v_dot2_f32_bf16 v77, v21, v80, v77
    v_dot2_f32_bf16 v79, v21, v21, v79
    v_dot2_f32_bf16 v76, v22, v80, v76
    v_dot2_f32_bf16 v78, v22, v22, v78
    v_dot2_f32_bf16 v77, v23, v80, v77
    v_dot2_f32_bf16 v79, v23, v23, v79
    v_dot2_f32_bf16 v76, v24, v80, v76
    v_dot2_f32_bf16 v78, v24, v24, v78
    v_dot2_f32_bf16 v77, v25, v80, v77
    v_dot2_f32_bf16 v79, v25, v25, v79
    v_dot2_f32_bf16 v76, v26, v80, v76
    v_dot2_f32_bf16 v78, v26, v26, v78
    v_dot2_f32_bf16 v77, v27, v80, v77
    v_dot2_f32_bf16 v79, v27, v27, v79
    v_dot2_f32_bf16 v76, v28, v80, v76
    v_dot2_f32_bf16 v78, v28, v28, v78
    v_dot2_f32_bf16 v77, v29, v80, v77
    v_dot2_f32_bf16 v79, v29, v29, v79
    v_dot2_f32_bf16 v76, v30, v80, v76
    v_dot2_f32_bf16 v78, v30, v30, v78
    v_dot2_f32_bf16 v77, v31, v80, v77
    v_dot2_f32_bf16 v79, v31, v31, v79
    v_dot2_f32_bf16 v76, v32, v80, v76
    v_dot2_f32_bf16 v78, v32, v32, v78
    v_dot2_f32_bf16 v77, v33, v80, v77
    v_dot2_f32_bf16 v79, v33, v33, v79
    v_dot2_f32_bf16 v76, v34, v80, v76
    v_dot2_f32_bf16 v78, v34, v34, v78
    v_dot2_f32_bf16 v77, v35, v80, v77
    v_dot2_f32_bf16 v79, v35, v35, v79
    v_dot2_f32_bf16 v76, v36, v80, v76
    v_dot2_f32_bf16 v78, v36, v36, v78
    v_dot2_f32_bf16 v77, v37, v80, v77
    v_dot2_f32_bf16 v79, v37, v37, v79
    v_dot2_f32_bf16 v76, v38, v80, v76
    v_dot2_f32_bf16 v78, v38, v38, v78
    v_dot2_f32_bf16 v77, v39, v80, v77
    v_dot2_f32_bf16 v79, v39, v39, v79
    v_dot2_f32_bf16 v76, v40, v80, v76
    v_dot2_f32_bf16 v78, v40, v40, v78
    v_dot2_f32_bf16 v77, v41, v80, v77
    v_dot2_f32_bf16 v79, v41, v41, v79
    v_dot2_f32_bf16 v76, v42, v80, v76
    v_dot2_f32_bf16 v78, v42, v42, v78
    v_dot2_f32_bf16 v77, v43, v80, v77
    v_dot2_f32_bf16 v79, v43, v43, v79
    s_nop 2
    v_add_f32 v76, v76, v77
    v_add_f32 v78, v78, v79
    s_nop 1
    v_add_f32_dpp v76, v76, v76 quad_perm:[1,0,3,2] row_mask:0xf bank_mask:0xf
    v_add_f32_dpp v78, v78, v78 quad_perm:[1,0,3,2] row_mask:0xf bank_mask:0xf
    s_nop 1
    v_add_f32_dpp v76, v76, v76 quad_perm:[2,3,0,1] row_mask:0xf bank_mask:0xf
    v_add_f32_dpp v78, v78, v78 quad_perm:[2,3,0,1] row_mask:0xf bank_mask:0xf
    s_nop 1
    v_add_f32_dpp v76, v76, v76 row_half_mirror row_mask:0xf bank_mask:0xf
    v_add_f32_dpp v78, v78, v78 row_half_mirror row_mask:0xf bank_mask:0xf
    v_mul_f32 v81, 0x3ae38e39, v76
    v_mul_f32 v82, 0x3ae38e39, v78
    v_fma_f32 v82, -v81, v81, v82
    v_max_f32 v82, 0, v82
    v_cvt_pk_bf16_f32 v83, v82, v82
    v_and_b32 v83, 0xffff0000, v83
    v_add_f32 v83, 0x3727c5ac, v83
    v_cvt_pk_bf16_f32 v83, v83, v83
    v_and_b32 v83, 0xffff0000, v83
    v_sqrt_f32 v83, v83
    s_nop 0
    v_cvt_pk_bf16_f32 v83, v83, v83
    v_and_b32 v83, 0xffff0000, v83
    v_cvt_pk_bf16_f32 v84, v81, v83
    v_mov_b32 v86, 163328
    s_mov_b32 s17, 262144
lw_40:
    ds_read_b32 v87, v86
    s_sub_u32 s17, s17, 1
    s_waitcnt lgkmcnt(0)
    v_readfirstlane_b32 s16, v87
    s_cmp_eq_u32 s17, 0
    s_cbranch_scc1 lwd_41
    s_cmp_ge_u32 s16, 1
    s_cbranch_scc1 lwd_41
    s_sleep 1
    s_branch lw_40
lwd_41:
    s_mov_b32 s15, s16
    v_mov_b32 v85, s15
    v_cmp_eq_u32 vcc, 0, v5
    s_cmp_ge_u32 s30, 256
    s_cbranch_scc1 nst_42
    s_lshl_b32 s16, s30, 6
    s_add_u32 s16, s16, 19202048
    s_and_saveexec_b64 s[28:29], vcc
    buffer_store_dwordx2 v[84:85], v3, s[8:11], s16 offen sc1
    s_mov_b64 exec, -1
nst_42:
    s_setprio 0
    v_mov_b32 v86, 163368
    v_mov_b32 v87, 1
    s_mov_b64 exec, 1
    ds_add_u32 v86, v87
    s_mov_b64 exec, -1
km_kernel_wpre:
    v_mov_b32 v4, 163328
    s_mov_b32 s17, 262144
lw_43:
    ds_read_b32 v5, v4
    s_sub_u32 s17, s17, 1
    s_waitcnt lgkmcnt(0)
    v_readfirstlane_b32 s16, v5
    s_cmp_eq_u32 s17, 0
    s_cbranch_scc1 lwd_44
    s_cmp_ge_u32 s16, 1
    s_cbranch_scc1 lwd_44
    s_sleep 1
    s_branch lw_43
lwd_44:
    s_mov_b32 s15, s16
    s_lshr_b32 s20, s12, 1
    s_lshl_b32 s20, s20, 4
    s_lshr_b32 s21, s13, 1
    s_add_u32 s20, s20, s21
    s_and_b32 s21, s12, 1
    s_lshl_b32 s21, s21, 1
    s_and_b32 s22, s13, 1
    s_add_u32 s21, s21, s22
    s_sub_u32 s22, s14, 3
    s_mul_i32 s23, s21, 9
    s_add_u32 s23, s23, s22
    s_mov_b32 s53, 0
    v_mov_b32 v122, 0
    s_cmp_lt_u32 s14, 3
    s_cbranch_scc1 km_kernel_c_poll
    s_mul_i32 s52, s22, 43
    s_lshr_b32 s52, s52, 7
    s_mul_i32 s53, s52, 3
    s_sub_u32 s53, s22, s53
    s_add_u32 s54, s53, 1
    s_cmp_eq_u32 s54, 3
    s_cselect_b32 s54, 0, s54
    s_add_u32 s55, s54, 1
    s_cmp_eq_u32 s55, 3
    s_cselect_b32 s55, 0, s55
    s_mul_i32 s24, s23, 18432
    s_add_u32 s24, s24, 19922944
    s_lshl_b32 s16, s53, 10
    s_add_u32 s56, s24, s16
    s_lshl_b32 s16, s54, 10
    s_add_u32 s57, s24, s16
    s_lshl_b32 s16, s55, 10
    s_add_u32 s58, s24, s16
    s_cmp_lt_u32 s13, 18
    s_cselect_b32 s50, 0, 114688
    v_mov_b32 v40, 0x3f803f80
    v_mov_b32 v41, 0x3f803f80
    v_mov_b32 v42, 0x3f803f80
    v_mov_b32 v43, 0x3f803f80
    v_mov_b32 v24, 0
    v_mov_b32 v25, 0
    v_mov_b32 v26, 0
    v_mov_b32 v27, 0
    v_mov_b32 v28, 0
    v_mov_b32 v29, 0
    v_mov_b32 v30, 0
    v_mov_b32 v31, 0
    v_mov_b32 v32, 0
    v_mov_b32 v33, 0
    v_mov_b32 v34, 0
    v_mov_b32 v35, 0
    s_cmp_eq_u32 s14, 3
    s_cbranch_scc1 km_kernel_w9
    s_cmp_lg_u32 s14, 6
    s_cbranch_scc1 nw12_45
    s_mov_b32 s24, 163504
    s_mov_b32 s25, 4
    s_cmp_lt_u32 s13, 18
    s_cselect_b32 s24, s24, 163368
    s_cselect_b32 s25, s25, 5
    v_mov_b32 v4, s24
    s_mov_b32 s17, 262144
lw_47:
    ds_read_b32 v5, v4
    s_sub_u32 s17, s17, 1
    s_waitcnt lgkmcnt(0)
    v_readfirstlane_b32 s16, v5
    s_cmp_eq_u32 s17, 0
    s_cbranch_scc1 lwd_48
    s_cmp_ge_u32 s16, s25
    s_cbranch_scc1 lwd_48
    s_sleep 4
    s_branch lw_47
lwd_48:
    v_min_u32 v4, 53, v3
    v_lshlrev_b32 v4, 7, v4
    v_add_u32 v5, 6912, v4
    v_add_u32 v6, 13824, v4
    s_mov_b32 s16, 19464192
    s_mov_b32 s17, 32768
poll_49:
    buffer_load_dword v8, v4, s[8:11], s16 offen sc1
    buffer_load_dword v9, v5, s[8:11], s16 offen sc1
    buffer_load_dword v10, v6, s[8:11], s16 offen sc1
    s_sub_u32 s17, s17, 1
    s_cmp_eq_u32 s17, 0
    s_waitcnt vmcnt(0)
    s_cbranch_scc1 pdone_50
    v_xor_b32 v8, s15, v8
    v_xor_b32 v9, s15, v9
    v_xor_b32 v10, s15, v10
    v_or_b32 v8, v8, v9
    v_or_b32 v8, v8, v10
    v_cmp_ne_u32 vcc, 0, v8
    s_nop 4
    s_cbranch_vccz pdone_50
    s_sleep 8
    s_branch poll_49
pdone_50:
    v_mov_b32 v4, 163448
    v_mov_b32 v5, 1
    s_mov_b64 exec, 1
    ds_add_u32 v4, v5
    s_mov_b64 exec, -1
nw12_45:
    s_cmp_ge_u32 s13, 18
    s_cbranch_scc1 pw_46
    v_mov_b32 v4, 163360
    s_mov_b32 s17, 262144
lw_51:
    ds_read_b32 v5, v4
    s_sub_u32 s17, s17, 1
    s_waitcnt lgkmcnt(0)
    v_readfirstlane_b32 s16, v5
    s_cmp_eq_u32 s17, 0
    s_cbranch_scc1 lwd_52
    s_cmp_ge_u32 s16, 4
    s_cbranch_scc1 lwd_52
    s_sleep 4
    s_branch lw_51
lwd_52:
    v_mov_b32 v4, 163456
    s_mov_b32 s17, 262144
lw_53:
    ds_read_b32 v5, v4
    s_sub_u32 s17, s17, 1
    s_waitcnt lgkmcnt(0)
    v_readfirstlane_b32 s16, v5
    s_cmp_eq_u32 s17, 0
    s_cbranch_scc1 lwd_54
    s_cmp_ge_u32 s16, 4
    s_cbranch_scc1 lwd_54
    s_sleep 4
    s_branch lw_53
lwd_54:
    s_branch pw_46x
pw_46:
    v_mov_b32 v4, 163384
    s_mov_b32 s17, 262144
lw_55:
    ds_read_b32 v5, v4
    s_sub_u32 s17, s17, 1
    s_waitcnt lgkmcnt(0)
    v_readfirstlane_b32 s16, v5
    s_cmp_eq_u32 s17, 0
    s_cbranch_scc1 lwd_56
    s_cmp_ge_u32 s16, 4
    s_cbranch_scc1 lwd_56
    s_sleep 4
    s_branch lw_55
lwd_56:
pw_46x:
    v_mov_b32 v4, 163448
    s_mov_b32 s17, 262144
lw_57:
    ds_read_b32 v5, v4
    s_sub_u32 s17, s17, 1
    s_waitcnt lgkmcnt(0)
    v_readfirstlane_b32 s16, v5
    s_cmp_eq_u32 s17, 0
    s_cbranch_scc1 lwd_58
    s_cmp_ge_u32 s16, 1
    s_cbranch_scc1 lwd_58
    s_sleep 4
    s_branch lw_57
lwd_58:
    s_cmp_ge_u32 s13, 18
    s_cbranch_scc1 km_kernel_wp2
    s_and_b32 s16, s14, 14
    s_cmp_lg_u32 s16, 4
    s_cbranch_scc1 km_kernel_wp2
    s_and_b32 s24, s14, 1
    s_mul_i32 s24, s24, 663552
    s_mul_i32 s25, s13, 18432
    s_add_u32 s24, s24, s25
    s_and_b32 s25, s12, 1
    s_mul_i32 s25, s25, 331776
    s_add_u32 s24, s24, s25
    s_add_u32 s24, s24, 19922944
    v_min_u32 v4, 47, v3
    v_lshlrev_b32 v4, 7, v4
    buffer_load_dword v44, v4, s[8:11], s24 offen sc1
    s_add_u32 s24, s24, 6144
    buffer_load_dword v45, v4, s[8:11], s24 offen sc1
    s_add_u32 s24, s24, 6144
    buffer_load_dword v46, v4, s[8:11], s24 offen sc1
    s_add_u32 s24, s24, 6144
km_kernel_wp2:
    buffer_load_dwordx4 v[48:51], v1, s[8:11], s56 offen offset:0 sc1
    buffer_load_dwordx4 v[52:55], v1, s[8:11], s57 offen offset:0 sc1
    buffer_load_dwordx4 v[56:59], v1, s[8:11], s58 offen offset:0 sc1
    buffer_load_dwordx4 v[60:63], v1, s[8:11], s56 offen offset:3072 sc1
    buffer_load_dwordx4 v[64:67], v1, s[8:11], s57 offen offset:3072 sc1
    buffer_load_dwordx4 v[68:71], v1, s[8:11], s58 offen offset:3072 sc1
    s_add_u32 s56, s56, 6144
    s_add_u32 s57, s57, 6144
    s_add_u32 s58, s58, 6144
    buffer_load_dwordx4 v[72:75], v1, s[8:11], s56 offen offset:0 sc1
    buffer_load_dwordx4 v[76:79], v1, s[8:11], s57 offen offset:0 sc1
    buffer_load_dwordx4 v[80:83], v1, s[8:11], s58 offen offset:0 sc1
    buffer_load_dwordx4 v[84:87], v1, s[8:11], s56 offen offset:3072 sc1
    buffer_load_dwordx4 v[88:91], v1, s[8:11], s57 offen offset:3072 sc1
    buffer_load_dwordx4 v[92:95], v1, s[8:11], s58 offen offset:3072 sc1
    s_add_u32 s56, s56, 6144
    s_add_u32 s57, s57, 6144
    s_add_u32 s58, s58, 6144
    buffer_load_dwordx4 v[96:99], v1, s[8:11], s56 offen offset:0 sc1
    buffer_load_dwordx4 v[100:103], v1, s[8:11], s57 offen offset:0 sc1
    buffer_load_dwordx4 v[104:107], v1, s[8:11], s58 offen offset:0 sc1
    buffer_load_dwordx4 v[108:111], v1, s[8:11], s56 offen offset:3072 sc1
    buffer_load_dwordx4 v[112:115], v1, s[8:11], s57 offen offset:3072 sc1
    buffer_load_dwordx4 v[116:119], v1, s[8:11], s58 offen offset:3072 sc1
    s_add_u32 s56, s56, 6144
    s_add_u32 s57, s57, 6144
    s_add_u32 s58, s58, 6144
    s_add_u32 s56, s56, 645120
    s_add_u32 s57, s57, 645120
    s_add_u32 s58, s58, 645120
    s_mul_i32 s24, s21, 165888
    s_add_u32 s24, s24, 19922944
    s_sub_u32 s25, s14, 4
    s_lshl_b32 s25, s25, 2
    s_add_u32 s16, s25, 0
    s_lshl_b32 s17, s16, 10
    s_add_u32 s26, s17, 645120
    s_cmp_ge_u32 s16, 18
    s_cselect_b32 s17, s26, s17
    s_add_u32 s17, s17, s24
    buffer_load_dwordx4 v[8:11], v1, s[8:11], s17 offen sc1
    s_add_u32 s16, s25, 1
    s_lshl_b32 s17, s16, 10
    s_add_u32 s26, s17, 645120
    s_cmp_ge_u32 s16, 18
    s_cselect_b32 s17, s26, s17
    s_add_u32 s17, s17, s24
    buffer_load_dwordx4 v[12:15], v1, s[8:11], s17 offen sc1
    s_add_u32 s16, s25, 2
    s_lshl_b32 s17, s16, 10
    s_add_u32 s26, s17, 645120
    s_cmp_ge_u32 s16, 18
    s_cselect_b32 s17, s26, s17
    s_add_u32 s17, s17, s24
    buffer_load_dwordx4 v[16:19], v1, s[8:11], s17 offen sc1
    s_add_u32 s16, s25, 3
    s_lshl_b32 s17, s16, 10
    s_add_u32 s26, s17, 645120
    s_cmp_ge_u32 s16, 18
    s_cselect_b32 s17, s26, s17
    s_add_u32 s17, s17, s24
    buffer_load_dwordx4 v[20:23], v1, s[8:11], s17 offen sc1
    s_lshl_b32 s25, s25, 10
    s_add_u32 s25, s25, s50
    v_add_u32 v4, s25, v1
    s_waitcnt vmcnt(0)
    ds_write_b128 v4, v[8:11] offset:0
    ds_write_b128 v4, v[12:15] offset:1024
    ds_write_b128 v4, v[16:19] offset:2048
    ds_write_b128 v4, v[20:23] offset:3072
    v_mov_b32 v36, 163460
    v_mov_b32 v37, 1
    s_mov_b64 exec, 1
    ds_add_u32 v36, v37
    s_mov_b64 exec, -1
    s_cmp_ge_u32 s13, 18
    s_cbranch_scc1 w2g_59
    v_mov_b32 v36, 163364
    s_mov_b32 s17, 262144
lw_60:
    ds_read_b32 v37, v36
    s_sub_u32 s17, s17, 1
    s_waitcnt lgkmcnt(0)
    v_readfirstlane_b32 s16, v37
    s_cmp_eq_u32 s17, 0
    s_cbranch_scc1 lwd_61
    s_cmp_ge_u32 s16, 4
    s_cbranch_scc1 lwd_61
    s_sleep 4
    s_branch lw_60
lwd_61:
w2g_59:
    buffer_load_dwordx4 v[132:135], v1, s[8:11], s56 offen offset:0 sc1
    buffer_load_dwordx4 v[136:139], v1, s[8:11], s57 offen offset:0 sc1
    buffer_load_dwordx4 v[140:143], v1, s[8:11], s58 offen offset:0 sc1
    buffer_load_dwordx4 v[144:147], v1, s[8:11], s56 offen offset:3072 sc1
    buffer_load_dwordx4 v[148:151], v1, s[8:11], s57 offen offset:3072 sc1
    buffer_load_dwordx4 v[152:155], v1, s[8:11], s58 offen offset:3072 sc1
    s_add_u32 s56, s56, 6144
    s_add_u32 s57, s57, 6144
    s_add_u32 s58, s58, 6144
    buffer_load_dwordx4 v[156:159], v1, s[8:11], s56 offen offset:0 sc1
    buffer_load_dwordx4 v[160:163], v1, s[8:11], s57 offen offset:0 sc1
    buffer_load_dwordx4 v[164:167], v1, s[8:11], s58 offen offset:0 sc1
    s_branch km_kernel_cs1
km_kernel_w9:
    s_waitcnt vmcnt(0)
    v_mov_b32 v4, 163460
    s_mov_b32 s17, 262144
lw_62:
    ds_read_b32 v5, v4
    s_sub_u32 s17, s17, 1
    s_waitcnt lgkmcnt(0)
    v_readfirstlane_b32 s16, v5
    s_cmp_eq_u32 s17, 0
    s_cbranch_scc1 lwd_63
    s_cmp_ge_u32 s16, 8
    s_cbranch_scc1 lwd_63
    s_sleep 2
    s_branch lw_62
lwd_63:
    v_add_u32 v4, s50, v1
    ds_read_b128 v[48:51], v4 offset:0
    ds_read_b128 v[52:55], v4 offset:1024
    ds_read_b128 v[56:59], v4 offset:2048
    ds_read_b128 v[60:63], v4 offset:3072
    ds_read_b128 v[64:67], v4 offset:4096
    ds_read_b128 v[68:71], v4 offset:5120
    ds_read_b128 v[72:75], v4 offset:6144
    ds_read_b128 v[76:79], v4 offset:7168
    ds_read_b128 v[80:83], v4 offset:8192
    ds_read_b128 v[84:87], v4 offset:9216
    ds_read_b128 v[88:91], v4 offset:10240
    ds_read_b128 v[92:95], v4 offset:11264
    ds_read_b128 v[96:99], v4 offset:12288
    ds_read_b128 v[100:103], v4 offset:13312
    ds_read_b128 v[104:107], v4 offset:14336
    ds_read_b128 v[108:111], v4 offset:15360
    ds_read_b128 v[112:115], v4 offset:16384
    ds_read_b128 v[116:119], v4 offset:17408
    ds_read_b128 v[132:135], v4 offset:18432
    ds_read_b128 v[136:139], v4 offset:19456
    ds_read_b128 v[140:143], v4 offset:20480
    ds_read_b128 v[144:147], v4 offset:21504
    ds_read_b128 v[148:151], v4 offset:22528
    ds_read_b128 v[152:155], v4 offset:23552
    ds_read_b128 v[156:159], v4 offset:24576
    ds_read_b128 v[160:163], v4 offset:25600
    ds_read_b128 v[164:167], v4 offset:26624
    s_add_u32 s56, s56, 669696
    s_add_u32 s57, s57, 669696
    s_add_u32 s58, s58, 669696
    s_waitcnt lgkmcnt(0)
km_kernel_cs1:
    v_mfma_f32_16x16x32_bf16 v[24:27], v[48:51], v[40:43], v[24:27]
    v_mfma_f32_16x16x32_bf16 v[28:31], v[52:55], v[40:43], v[28:31]
    v_mfma_f32_16x16x32_bf16 v[32:35], v[56:59], v[40:43], v[32:35]
    v_mfma_f32_16x16x32_bf16 v[24:27], v[60:63], v[40:43], v[24:27]
    v_mfma_f32_16x16x32_bf16 v[28:31], v[64:67], v[40:43], v[28:31]
    v_mfma_f32_16x16x32_bf16 v[32:35], v[68:71], v[40:43], v[32:35]
    v_mfma_f32_16x16x32_bf16 v[24:27], v[72:75], v[40:43], v[24:27]
    v_mfma_f32_16x16x32_bf16 v[28:31], v[76:79], v[40:43], v[28:31]
    v_mfma_f32_16x16x32_bf16 v[32:35], v[80:83], v[40:43], v[32:35]
    v_mfma_f32_16x16x32_bf16 v[24:27], v[84:87], v[40:43], v[24:27]
    v_mfma_f32_16x16x32_bf16 v[28:31], v[88:91], v[40:43], v[28:31]
    v_mfma_f32_16x16x32_bf16 v[32:35], v[92:95], v[40:43], v[32:35]
    v_mfma_f32_16x16x32_bf16 v[24:27], v[96:99], v[40:43], v[24:27]
    v_mfma_f32_16x16x32_bf16 v[28:31], v[100:103], v[40:43], v[28:31]
    v_mfma_f32_16x16x32_bf16 v[32:35], v[104:107], v[40:43], v[32:35]
    v_mfma_f32_16x16x32_bf16 v[24:27], v[108:111], v[40:43], v[24:27]
    v_mfma_f32_16x16x32_bf16 v[28:31], v[112:115], v[40:43], v[28:31]
    v_mfma_f32_16x16x32_bf16 v[32:35], v[116:119], v[40:43], v[32:35]
    v_and_b32 v4, 15, v3
    v_cmp_eq_u32 vcc, 0, v4
    v_and_b32 v4, 48, v3
    s_mul_i32 s24, s52, 576
    s_lshl_b32 s25, s53, 6
    s_add_u32 s24, s24, s25
    s_add_u32 s24, s24, 158848
    s_mul_i32 s25, s53, 192
    s_add_u32 s25, s25, s24
    v_add_u32 v5, s25, v4
    s_mul_i32 s25, s54, 192
    s_add_u32 s25, s25, s24
    v_add_u32 v6, s25, v4
    s_mul_i32 s25, s55, 192
    s_add_u32 s25, s25, s24
    v_add_u32 v7, s25, v4
    s_and_saveexec_b64 s[26:27], vcc
    ds_write_b128 v5, v[24:27]
    ds_write_b128 v6, v[28:31]
    ds_write_b128 v7, v[32:35]
    s_mov_b64 exec, -1
    s_mul_i32 s24, s52, 12288
    s_add_u32 s24, s24, 38912
    s_lshl_b32 s25, s54, 12
    s_add_u32 s25, s25, s24
    v_add_u32 v0, s25, v1
    s_lshl_b32 s25, s55, 12
    s_add_u32 s25, s25, s24
    v_add_u32 v120, s25, v1
    s_lshl_b32 s25, s53, 12
    s_add_u32 s25, s25, s24
    v_add_u32 v121, s25, v1
    s_lshl_b32 s59, s52, 2
    s_add_u32 s59, s59, 163472
    s_mul_i32 s16, s22, 192
    s_add_u32 s16, s16, 158848
    v_add_u32 v125, s16, v4
    s_lshl_b32 s24, s23, 9
    s_add_u32 s60, s24, 9437184
    s_lshr_b32 s24, s21, 1
    s_add_u32 s24, s24, 1
    s_sub_u32 s16, 0, s24
    s_bitcmp1_b32 s21, 0
    s_cselect_b32 s24, s16, s24
    s_lshl_b32 s16, s20, 5
    s_add_u32 s24, s24, s16
    v_and_b32 v5, 31, v3
    v_add_u32 v5, s24, v5
    v_cmp_gt_u32 vcc, 2048, v5
    v_and_b32 v5, 2047, v5
    v_lshrrev_b32 v6, 4, v5
    v_cndmask_b32 v123, 0, -1, vcc
    v_mul_u32_u24 v6, 18432, v6
    v_and_b32 v5, 15, v5
    v_lshl_add_u32 v6, v5, 4, v6
    v_lshrrev_b32 v5, 5, v3
    v_lshl_add_u32 v122, v5, 8, v6
    v_and_b32 v4, 15, v3
    v_lshlrev_b32 v124, 5, v4
    s_lshl_b32 s61, s20, 2
    s_add_u32 s61, s61, s21
    s_lshl_b32 s61, s61, 7
    s_add_u32 s62, s61, 19333120
    s_add_u32 s61, s61, 19300352
    v_mov_b32 v126, s59
    v_mov_b32 v127, 1
    s_waitcnt vmcnt(0)
    v_mov_b32 v36, 163464
    v_mov_b32 v37, 1
    s_mov_b64 exec, 1
    ds_add_u32 v36, v37
    s_mov_b64 exec, -1
    s_branch km_kernel_c0
km_kernel_c_poll:
    s_cmp_lg_u32 s14, 2
    s_cbranch_scc1 km_kernel_c0
    v_min_u32 v4, 47, v3
    s_mul_i32 s16, s12, 9472
    v_lshl_add_u32 v4, v4, 5, s16
    v_add_u32 v5, 1536, v4
    v_add_u32 v6, 3072, v4
    v_mov_b32 v8, 163464
    s_mov_b32 s17, 262144
lw_64:
    ds_read_b32 v9, v8
    s_sub_u32 s17, s17, 1
    s_waitcnt lgkmcnt(0)
    v_readfirstlane_b32 s16, v9
    s_cmp_eq_u32 s17, 0
    s_cbranch_scc1 lwd_65
    s_cmp_ge_u32 s16, 8
    s_cbranch_scc1 lwd_65
    s_sleep 2
    s_branch lw_64
lwd_65:
    s_mov_b32 s16, 19218432
    s_mov_b32 s17, 32768
poll_66:
    buffer_load_dword v100, v4, s[8:11], s16 offen sc1
    buffer_load_dword v101, v5, s[8:11], s16 offen sc1
    buffer_load_dword v102, v6, s[8:11], s16 offen sc1
    s_sub_u32 s17, s17, 1
    s_cmp_eq_u32 s17, 0
    s_waitcnt vmcnt(0)
    s_cbranch_scc1 pdone_67
    v_xor_b32 v100, s15, v100
    v_xor_b32 v101, s15, v101
    v_xor_b32 v102, s15, v102
    v_or_b32 v100, v100, v101
    v_or_b32 v100, v100, v102
    v_cmp_ne_u32 vcc, 0, v100
    s_nop 4
    s_cbranch_vccz pdone_67
    s_sleep 1
    s_branch poll_66
pdone_67:
km_kernel_c0:
    v_lshrrev_b32 v4, 2, v3
    v_and_b32 v5, 3, v3
    v_lshlrev_b32 v6, 12, v4
    v_lshl_add_u32 v6, v5, 4, v6
    v_lshrrev_b32 v7, 4, v3
    v_and_b32 v7, 2, v7
    v_xor_b32 v5, v5, v7
    v_lshlrev_b32 v4, 6, v4
    v_lshl_add_u32 v4, v5, 4, v4
    s_mul_i32 s16, s14, 3072
    v_add_u32 v4, s16, v4
    s_mul_i32 s24, s14, 196608
    s_lshl_b32 s25, s20, 6
    s_add_u32 s24, s24, s25
    s_add_u32 s24, s24, 4718592
    v_lshrrev_b32 v2, 4, v3
    v_bfe_u32 v5, v3, 2, 2
    v_lshl_add_u32 v5, v2, 3, v5
    v_lshlrev_b32 v5, 6, v5
    v_and_b32 v7, 3, v3
    v_lshl_add_u32 v5, v7, 3, v5
    v_and_b32 v7, 1, v2
    v_lshl_add_u32 v5, v7, 5, v5
    s_mul_i32 s16, s53, 12288
    v_add_u32 v5, s16, v5
    v_xor_b32 v7, 32, v5
    v_mov_b32 v20, 0
    v_mov_b32 v21, 0
    v_mov_b32 v22, 0
    v_mov_b32 v23, 0
    v_mov_b32 v24, 0
    v_mov_b32 v25, 0
    v_mov_b32 v26, 0
    v_mov_b32 v27, 0
    v_mov_b32 v28, 0
    v_mov_b32 v29, 0
    v_mov_b32 v30, 0
    v_mov_b32 v31, 0
    s_waitcnt lgkmcnt(0)
    s_barrier
    buffer_load_dwordx4 v[32:35], v6, s[8:11], s24 offen sc1
    s_add_u32 s24, s24, 65536
    buffer_load_dwordx4 v[36:39], v6, s[8:11], s24 offen sc1
    s_add_u32 s24, s24, 65536
    buffer_load_dwordx4 v[40:43], v6, s[8:11], s24 offen sc1
    s_cmp_lt_u32 s14, 3
    s_cbranch_scc1 ncs_68
    ds_read_b128 v[8:11], v125 offset:0
    ds_read_b128 v[12:15], v125 offset:64
    ds_read_b128 v[16:19], v125 offset:128
    s_waitcnt lgkmcnt(0)
    v_add_f32 v128, v8, v12
    v_add_f32 v128, v128, v16
    v_add_f32 v129, v9, v13
    v_add_f32 v129, v129, v17
    v_add_f32 v130, v10, v14
    v_add_f32 v130, v130, v18
    v_add_f32 v131, v11, v15
    v_add_f32 v131, v131, v19
ncs_68:
    v_mov_b32 v8, 0
    v_mov_b32 v9, 0
    v_mov_b32 v10, 0
    v_mov_b32 v11, 0
    v_mov_b32 v12, 0
    v_mov_b32 v13, 0
    v_mov_b32 v14, 0
    v_mov_b32 v15, 0
    v_mov_b32 v16, 0
    v_mov_b32 v17, 0
    v_mov_b32 v18, 0
    v_mov_b32 v19, 0
    s_waitcnt vmcnt(2)
    ds_write_b128 v4, v[32:35] offset:0
    s_waitcnt vmcnt(1)
    ds_write_b128 v4, v[36:39] offset:1024
    s_waitcnt vmcnt(0)
    ds_write_b128 v4, v[40:43] offset:2048
    s_waitcnt lgkmcnt(0)
    s_barrier
    s_cmp_lt_u32 s14, 3
    s_cbranch_scc1 km_kernel_c_aux
    s_setprio 1
    ds_read_b64_tr_b16 v[32:33], v5 offset:0
    ds_read_b64_tr_b16 v[34:35], v5 offset:256
    ds_read_b64_tr_b16 v[36:37], v7 offset:0
    ds_read_b64_tr_b16 v[38:39], v7 offset:256
    ds_read_b64_tr_b16 v[40:41], v5 offset:2048
    ds_read_b64_tr_b16 v[42:43], v5 offset:2304
    ds_read_b64_tr_b16 v[44:45], v7 offset:2048
    ds_read_b64_tr_b16 v[46:47], v7 offset:2304
    s_waitcnt lgkmcnt(4)
    v_mfma_f32_16x16x32_bf16 v[16:19], v[52:55], v[32:35], v[16:19]
    v_mfma_f32_16x16x32_bf16 v[20:23], v[52:55], v[36:39], v[20:23]
    v_mfma_f32_16x16x32_bf16 v[24:27], v[56:59], v[32:35], v[24:27]
    v_mfma_f32_16x16x32_bf16 v[28:31], v[56:59], v[36:39], v[28:31]
    v_mfma_f32_16x16x32_bf16 v[8:11], v[48:51], v[32:35], v[8:11]
    v_mfma_f32_16x16x32_bf16 v[12:15], v[48:51], v[36:39], v[12:15]
    buffer_load_dwordx4 v[48:51], v1, s[8:11], s56 offen offset:3072 sc1
    buffer_load_dwordx4 v[52:55], v1, s[8:11], s57 offen offset:3072 sc1
    buffer_load_dwordx4 v[56:59], v1, s[8:11], s58 offen offset:3072 sc1
    s_add_u32 s56, s56, 6144
    s_add_u32 s57, s57, 6144
    s_add_u32 s58, s58, 6144
    ds_read_b64_tr_b16 v[32:33], v5 offset:4096
    ds_read_b64_tr_b16 v[34:35], v5 offset:4352
    ds_read_b64_tr_b16 v[36:37], v7 offset:4096
    ds_read_b64_tr_b16 v[38:39], v7 offset:4352
    s_waitcnt lgkmcnt(4)
    v_mfma_f32_16x16x32_bf16 v[16:19], v[64:67], v[40:43], v[16:19]
    v_mfma_f32_16x16x32_bf16 v[20:23], v[64:67], v[44:47], v[20:23]
    v_mfma_f32_16x16x32_bf16 v[24:27], v[68:71], v[40:43], v[24:27]
    v_mfma_f32_16x16x32_bf16 v[28:31], v[68:71], v[44:47], v[28:31]
    v_mfma_f32_16x16x32_bf16 v[8:11], v[60:63], v[40:43], v[8:11]
    v_mfma_f32_16x16x32_bf16 v[12:15], v[60:63], v[44:47], v[12:15]
    buffer_load_dwordx4 v[60:63], v1, s[8:11], s56 offen offset:0 sc1
    buffer_load_dwordx4 v[64:67], v1, s[8:11], s57 offen offset:0 sc1
    buffer_load_dwordx4 v[68:71], v1, s[8:11], s58 offen offset:0 sc1
    ds_read_b64_tr_b16 v[40:41], v5 offset:6144
    ds_read_b64_tr_b16 v[42:43], v5 offset:6400
    ds_read_b64_tr_b16 v[44:45], v7 offset:6144
    ds_read_b64_tr_b16 v[46:47], v7 offset:6400
    s_waitcnt lgkmcnt(4)
    v_mfma_f32_16x16x32_bf16 v[16:19], v[76:79], v[32:35], v[16:19]
    v_mfma_f32_16x16x32_bf16 v[20:23], v[76:79], v[36:39], v[20:23]
    v_mfma_f32_16x16x32_bf16 v[24:27], v[80:83], v[32:35], v[24:27]
    v_mfma_f32_16x16x32_bf16 v[28:31], v[80:83], v[36:39], v[28:31]
    v_mfma_f32_16x16x32_bf16 v[8:11], v[72:75], v[32:35], v[8:11]
    v_mfma_f32_16x16x32_bf16 v[12:15], v[72:75], v[36:39], v[12:15]
    buffer_load_dwordx4 v[72:75], v1, s[8:11], s56 offen offset:3072 sc1
    buffer_load_dwordx4 v[76:79], v1, s[8:11], s57 offen offset:3072 sc1
    buffer_load_dwordx4 v[80:83], v1, s[8:11], s58 offen offset:3072 sc1
    s_add_u32 s56, s56, 6144
    s_add_u32 s57, s57, 6144
    s_add_u32 s58, s58, 6144
    ds_read_b64_tr_b16 v[32:33], v5 offset:8192
    ds_read_b64_tr_b16 v[34:35], v5 offset:8448
    ds_read_b64_tr_b16 v[36:37], v7 offset:8192
    ds_read_b64_tr_b16 v[38:39], v7 offset:8448
    s_waitcnt lgkmcnt(4)
    v_mfma_f32_16x16x32_bf16 v[16:19], v[88:91], v[40:43], v[16:19]
    v_mfma_f32_16x16x32_bf16 v[20:23], v[88:91], v[44:47], v[20:23]
    v_mfma_f32_16x16x32_bf16 v[24:27], v[92:95], v[40:43], v[24:27]
    v_mfma_f32_16x16x32_bf16 v[28:31], v[92:95], v[44:47], v[28:31]
    v_mfma_f32_16x16x32_bf16 v[8:11], v[84:87], v[40:43], v[8:11]
    v_mfma_f32_16x16x32_bf16 v[12:15], v[84:87], v[44:47], v[12:15]
    ds_read_b64_tr_b16 v[40:41], v5 offset:10240
    ds_read_b64_tr_b16 v[42:43], v5 offset:10496
    ds_read_b64_tr_b16 v[44:45], v7 offset:10240
    ds_read_b64_tr_b16 v[46:47], v7 offset:10496
    s_waitcnt lgkmcnt(4)
    v_mfma_f32_16x16x32_bf16 v[16:19], v[100:103], v[32:35], v[16:19]
    v_mfma_f32_16x16x32_bf16 v[20:23], v[100:103], v[36:39], v[20:23]
    v_mfma_f32_16x16x32_bf16 v[24:27], v[104:107], v[32:35], v[24:27]
    v_mfma_f32_16x16x32_bf16 v[28:31], v[104:107], v[36:39], v[28:31]
    v_mfma_f32_16x16x32_bf16 v[8:11], v[96:99], v[32:35], v[8:11]
    v_mfma_f32_16x16x32_bf16 v[12:15], v[96:99], v[36:39], v[12:15]
    s_waitcnt lgkmcnt(0)
    v_mfma_f32_16x16x32_bf16 v[16:19], v[112:115], v[40:43], v[16:19]
    v_mfma_f32_16x16x32_bf16 v[20:23], v[112:115], v[44:47], v[20:23]
    v_mfma_f32_16x16x32_bf16 v[24:27], v[116:119], v[40:43], v[24:27]
    v_mfma_f32_16x16x32_bf16 v[28:31], v[116:119], v[44:47], v[28:31]
    v_mfma_f32_16x16x32_bf16 v[8:11], v[108:111], v[40:43], v[8:11]
    v_mfma_f32_16x16x32_bf16 v[12:15], v[108:111], v[44:47], v[12:15]
    v_mov_b32 v5, 163388
    s_nop 3
    ds_write_b128 v0, v[16:19] offset:0
    ds_write_b128 v0, v[20:23] offset:1024
    ds_write_b128 v120, v[24:27] offset:2048
    ds_write_b128 v120, v[28:31] offset:3072
    s_mov_b64 exec, 1
    ds_add_u32 v126, v127
    s_mov_b64 exec, -1
    s_setprio 0
    s_mov_b32 s17, 262144
xr_69:
    ds_read_b32 v4, v126
    ds_read_b32 v6, v5
    ds_read_b128 v[16:19], v121 offset:0
    ds_read_b128 v[20:23], v121 offset:1024
    ds_read_b128 v[24:27], v121 offset:2048
    ds_read_b128 v[28:31], v121 offset:3072
    ds_read_b128 v[88:91], v124 offset:36864
    ds_read_b128 v[96:99], v124 offset:37376
    s_sub_u32 s17, s17, 1
    s_waitcnt lgkmcnt(0)
    v_lshl_add_u32 v4, v6, 4, v4
    s_cmp_eq_u32 s17, 0
    s_cbranch_scc1 xrd_70
    v_readfirstlane_b32 s16, v4
    s_nop 0
    s_cmp_eq_u32 s16, 35
    s_cbranch_scc1 xrd_70
    s_sleep 1
    s_branch xr_69
xrd_70:
    v_add_f32 v8, v8, v16
    v_add_f32 v9, v9, v17
    v_add_f32 v10, v10, v18
    v_add_f32 v11, v11, v19
    v_add_f32 v12, v12, v20
    v_add_f32 v13, v13, v21
    v_add_f32 v14, v14, v22
    v_add_f32 v15, v15, v23
    v_add_f32 v8, v8, v24
    v_add_f32 v9, v9, v25
    v_add_f32 v10, v10, v26
    v_add_f32 v11, v11, v27
    v_add_f32 v12, v12, v28
    v_add_f32 v13, v13, v29
    v_add_f32 v14, v14, v30
    v_add_f32 v15, v15, v31
    v_fma_f32 v8, -v88, v128, v8
    v_fma_f32 v9, -v88, v129, v9
    v_fma_f32 v10, -v88, v130, v10
    v_fma_f32 v11, -v88, v131, v11
    v_mul_f32 v104, v8, v8
    v_mul_f32 v105, v9, v9
    v_mul_f32 v106, v10, v10
    v_mul_f32 v107, v11, v11
    v_fma_f32 v104, v104, v90, v89
    v_fma_f32 v105, v105, v90, v89
    v_fma_f32 v106, v106, v90, v89
    v_fma_f32 v107, v107, v90, v89
    v_mul_f32 v104, v8, v104
    v_mul_f32 v105, v9, v105
    v_mul_f32 v106, v10, v106
    v_mul_f32 v107, v11, v107
    v_exp_f32 v104, v104
    v_exp_f32 v105, v105
    v_exp_f32 v106, v106
    v_exp_f32 v107, v107
    v_fma_f32 v104, v104, v91, v91
    v_fma_f32 v105, v105, v91, v91
    v_fma_f32 v106, v106, v91, v91
    v_fma_f32 v107, v107, v91, v91
    v_rcp_f32 v104, v104
    v_rcp_f32 v105, v105
    v_rcp_f32 v106, v106
    v_rcp_f32 v107, v107
    v_mul_f32 v8, v8, v104
    v_mul_f32 v9, v9, v105
    v_mul_f32 v10, v10, v106
    v_mul_f32 v11, v11, v107
    v_cvt_pk_bf16_f32 v108, v8, v9
    v_cvt_pk_bf16_f32 v109, v10, v11
    v_fma_f32 v12, -v96, v128, v12
    v_fma_f32 v13, -v96, v129, v13
    v_fma_f32 v14, -v96, v130, v14
    v_fma_f32 v15, -v96, v131, v15
    v_mul_f32 v104, v12, v12
    v_mul_f32 v105, v13, v13
    v_mul_f32 v106, v14, v14
    v_mul_f32 v107, v15, v15
    v_fma_f32 v104, v104, v98, v97
    v_fma_f32 v105, v105, v98, v97
    v_fma_f32 v106, v106, v98, v97
    v_fma_f32 v107, v107, v98, v97
    v_mul_f32 v104, v12, v104
    v_mul_f32 v105, v13, v105
    v_mul_f32 v106, v14, v106
    v_mul_f32 v107, v15, v107
    v_exp_f32 v104, v104
    v_exp_f32 v105, v105
    v_exp_f32 v106, v106
    v_exp_f32 v107, v107
    v_fma_f32 v104, v104, v99, v99
    v_fma_f32 v105, v105, v99, v99
    v_fma_f32 v106, v106, v99, v99
    v_fma_f32 v107, v107, v99, v99
    v_rcp_f32 v104, v104
    v_rcp_f32 v105, v105
    v_rcp_f32 v106, v106
    v_rcp_f32 v107, v107
    v_mul_f32 v12, v12, v104
    v_mul_f32 v13, v13, v105
    v_mul_f32 v14, v14, v106
    v_mul_f32 v15, v15, v107
    v_cvt_pk_bf16_f32 v110, v12, v13
    v_cvt_pk_bf16_f32 v111, v14, v15
    s_nop 1
    v_permlane16_swap_b32 v108, v110
    v_permlane16_swap_b32 v109, v111
    v_and_b32 v108, v108, v123
    v_and_b32 v109, v109, v123
    v_and_b32 v110, v110, v123
    v_and_b32 v111, v111, v123
    buffer_store_dwordx4 v[108:111], v122, s[8:11], s60 offen sc1
    s_waitcnt vmcnt(0)
    v_mov_b32 v112, 163372
    v_mov_b32 v113, 1
    s_mov_b64 exec, 1
    ds_add_rtn_u32 v113, v112, v113
    s_waitcnt lgkmcnt(0)
    v_readfirstlane_b32 s16, v113
    v_mov_b32 v112, s15
    s_cmp_lg_u32 s16, 8
    s_cbranch_scc1 sig_71
    buffer_store_dword v112, off, s[8:11], s61 sc1
sig_71:
    s_mov_b64 exec, -1
    v_mov_b32 v112, 163372
    s_mov_b32 s17, 262144
lw_72:
    ds_read_b32 v113, v112
    s_sub_u32 s17, s17, 1
    s_waitcnt lgkmcnt(0)
    v_readfirstlane_b32 s16, v113
    s_cmp_eq_u32 s17, 0
    s_cbranch_scc1 lwd_73
    s_cmp_ge_u32 s16, 9
    s_cbranch_scc1 lwd_73
    s_sleep 2
    s_branch lw_72
lwd_73:
    v_lshrrev_b32 v4, 2, v3
    v_lshlrev_b32 v4, 6, v4
    v_and_b32 v6, 3, v3
    v_lshl_add_u32 v4, v6, 3, v4
    v_and_b32 v6, 32, v3
    s_lshl_b32 s16, s23, 10
    v_add3_u32 v4, v4, v6, s16
    v_xor_b32 v6, 32, v4
    ds_read_b64_tr_b16 v[84:85], v4
    ds_read_b64_tr_b16 v[86:87], v6
    ds_read_b64 v[92:93], v124 offset:36880
    ds_read_b64 v[100:101], v124 offset:37392
    v_and_b32 v4, 15, v3
    v_lshlrev_b32 v4, 4, v4
    v_bfe_u32 v6, v3, 4, 1
    v_mul_u32_u24 v6, 18432, v6
    v_lshrrev_b32 v5, 5, v3
    v_lshl_add_u32 v4, v5, 8, v4
    v_add_u32 v122, v4, v6
    s_mul_i32 s60, s20, 36864
    s_lshl_b32 s24, s23, 9
    s_add_u32 s60, s60, s24
    s_add_u32 s60, s60, 11796480
    v_add_u32 v126, 16, v126
    s_mul_i32 s16, s53, 6144
    v_add_u32 v5, s16, v1
    s_waitcnt lgkmcnt(0)
    v_lshlrev_b32 v8, 16, v84
    v_and_b32 v9, 0xffff0000, v84
    v_lshlrev_b32 v10, 16, v85
    v_and_b32 v11, 0xffff0000, v85
    v_sub_f32 v8, v8, v92
    v_sub_f32 v9, v9, v92
    v_sub_f32 v10, v10, v92
    v_sub_f32 v11, v11, v92
    v_cvt_pk_bf16_f32 v84, v8, v9
    v_cvt_pk_bf16_f32 v85, v10, v11
    v_lshlrev_b32 v8, 16, v84
    v_and_b32 v9, 0xffff0000, v84
    v_lshlrev_b32 v10, 16, v85
    v_and_b32 v11, 0xffff0000, v85
    v_mul_f32 v8, v8, v93
    v_mul_f32 v9, v9, v93
    v_mul_f32 v10, v10, v93
    v_mul_f32 v11, v11, v93
    v_cvt_pk_bf16_f32 v84, v8, v9
    v_cvt_pk_bf16_f32 v85, v10, v11
    v_lshlrev_b32 v8, 16, v84
    v_and_b32 v9, 0xffff0000, v84
    v_lshlrev_b32 v10, 16, v85
    v_and_b32 v11, 0xffff0000, v85
    v_lshlrev_b32 v12, 16, v86
    v_and_b32 v13, 0xffff0000, v86
    v_lshlrev_b32 v14, 16, v87
    v_and_b32 v15, 0xffff0000, v87
    v_sub_f32 v12, v12, v100
    v_sub_f32 v13, v13, v100
    v_sub_f32 v14, v14, v100
    v_sub_f32 v15, v15, v100
    v_cvt_pk_bf16_f32 v86, v12, v13
    v_cvt_pk_bf16_f32 v87, v14, v15
    v_lshlrev_b32 v12, 16, v86
    v_and_b32 v13, 0xffff0000, v86
    v_lshlrev_b32 v14, 16, v87
    v_and_b32 v15, 0xffff0000, v87
    v_mul_f32 v12, v12, v101
    v_mul_f32 v13, v13, v101
    v_mul_f32 v14, v14, v101
    v_mul_f32 v15, v15, v101
    v_cvt_pk_bf16_f32 v86, v12, v13
    v_cvt_pk_bf16_f32 v87, v14, v15
    v_lshlrev_b32 v12, 16, v86
    v_and_b32 v13, 0xffff0000, v86
    v_lshlrev_b32 v14, 16, v87
    v_and_b32 v15, 0xffff0000, v87
    v_mov_b32 v16, 0
    v_mov_b32 v17, 0
    v_mov_b32 v18, 0
    v_mov_b32 v19, 0
    v_mov_b32 v20, 0
    v_mov_b32 v21, 0
    v_mov_b32 v22, 0
    v_mov_b32 v23, 0
    v_mov_b32 v24, 0
    v_mov_b32 v25, 0
    v_mov_b32 v26, 0
    v_mov_b32 v27, 0
    v_mov_b32 v28, 0
    v_mov_b32 v29, 0
    v_mov_b32 v30, 0
    v_mov_b32 v31, 0
    s_branch km_kernel_d_pre
km_kernel_c_aux:
    s_lshl_b32 s27, s20, 2
    s_add_u32 s27, s27, s21
    s_lshl_b32 s27, s27, 7
    s_add_u32 s27, s27, 19333120
    s_cmp_eq_u32 s14, 2
    s_cbranch_scc1 km_kernel_c_hf
    s_setprio 2
    v_mov_b32 v16, 0x3f803f80
    v_mov_b32 v17, 0x3f803f80
    v_mov_b32 v18, 0x3f803f80
    v_mov_b32 v19, 0x3f803f80
    s_lshl_b32 s16, s14, 5
    v_xor_b32 v4, s16, v5
    ds_read_b64_tr_b16 v[24:25], v4 offset:0
    ds_read_b64_tr_b16 v[26:27], v4 offset:256
    ds_read_b64_tr_b16 v[28:29], v4 offset:2048
    ds_read_b64_tr_b16 v[30:31], v4 offset:2304
    ds_read_b64_tr_b16 v[32:33], v4 offset:4096
    ds_read_b64_tr_b16 v[34:35], v4 offset:4352
    ds_read_b64_tr_b16 v[36:37], v4 offset:6144
    ds_read_b64_tr_b16 v[38:39], v4 offset:6400
    ds_read_b64_tr_b16 v[40:41], v4 offset:8192
    ds_read_b64_tr_b16 v[42:43], v4 offset:8448
    ds_read_b64_tr_b16 v[44:45], v4 offset:10240
    ds_read_b64_tr_b16 v[46:47], v4 offset:10496
    ds_read_b64_tr_b16 v[48:49], v4 offset:12288
    ds_read_b64_tr_b16 v[50:51], v4 offset:12544
    s_waitcnt lgkmcnt(12)
    v_mfma_f32_16x16x32_bf16 v[8:11], v[24:27], v[24:27], v[8:11]
    v_mfma_f32_16x16x32_bf16 v[12:15], v[16:19], v[24:27], v[12:15]
    ds_read_b64_tr_b16 v[52:53], v4 offset:14336
    ds_read_b64_tr_b16 v[54:55], v4 offset:14592
    s_waitcnt lgkmcnt(12)
    v_mfma_f32_16x16x32_bf16 v[8:11], v[28:31], v[28:31], v[8:11]
    v_mfma_f32_16x16x32_bf16 v[12:15], v[16:19], v[28:31], v[12:15]
    ds_read_b64_tr_b16 v[56:57], v4 offset:16384
    ds_read_b64_tr_b16 v[58:59], v4 offset:16640
    s_waitcnt lgkmcnt(12)
    v_mfma_f32_16x16x32_bf16 v[8:11], v[32:35], v[32:35], v[8:11]
    v_mfma_f32_16x16x32_bf16 v[12:15], v[16:19], v[32:35], v[12:15]
    ds_read_b64_tr_b16 v[60:61], v4 offset:18432
    ds_read_b64_tr_b16 v[62:63], v4 offset:18688
    s_waitcnt lgkmcnt(12)
    v_mfma_f32_16x16x32_bf16 v[8:11], v[36:39], v[36:39], v[8:11]
    v_mfma_f32_16x16x32_bf16 v[12:15], v[16:19], v[36:39], v[12:15]
    ds_read_b64_tr_b16 v[64:65], v4 offset:20480
    ds_read_b64_tr_b16 v[66:67], v4 offset:20736
    s_waitcnt lgkmcnt(12)
    v_mfma_f32_16x16x32_bf16 v[8:11], v[40:43], v[40:43], v[8:11]
    v_mfma_f32_16x16x32_bf16 v[12:15], v[16:19], v[40:43], v[12:15]
    ds_read_b64_tr_b16 v[68:69], v4 offset:22528
    ds_read_b64_tr_b16 v[70:71], v4 offset:22784
    s_waitcnt lgkmcnt(12)
    v_mfma_f32_16x16x32_bf16 v[8:11], v[44:47], v[44:47], v[8:11]
    v_mfma_f32_16x16x32_bf16 v[12:15], v[16:19], v[44:47], v[12:15]
    ds_read_b64_tr_b16 v[72:73], v4 offset:24576
    ds_read_b64_tr_b16 v[74:75], v4 offset:24832
    s_waitcnt lgkmcnt(12)
    v_mfma_f32_16x16x32_bf16 v[8:11], v[48:51], v[48:51], v[8:11]
    v_mfma_f32_16x16x32_bf16 v[12:15], v[16:19], v[48:51], v[12:15]
    ds_read_b64_tr_b16 v[76:77], v4 offset:26624
    ds_read_b64_tr_b16 v[78:79], v4 offset:26880
    s_waitcnt lgkmcnt(12)
    v_mfma_f32_16x16x32_bf16 v[8:11], v[52:55], v[52:55], v[8:11]
    v_mfma_f32_16x16x32_bf16 v[12:15], v[16:19], v[52:55], v[12:15]
    ds_read_b64_tr_b16 v[80:81], v4 offset:28672
    ds_read_b64_tr_b16 v[82:83], v4 offset:28928
    s_waitcnt lgkmcnt(12)
    v_mfma_f32_16x16x32_bf16 v[8:11], v[56:59], v[56:59], v[8:11]
    v_mfma_f32_16x16x32_bf16 v[12:15], v[16:19], v[56:59], v[12:15]
    ds_read_b64_tr_b16 v[84:85], v4 offset:30720
    ds_read_b64_tr_b16 v[86:87], v4 offset:30976
    s_waitcnt lgkmcnt(12)
    v_mfma_f32_16x16x32_bf16 v[8:11], v[60:63], v[60:63], v[8:11]
    v_mfma_f32_16x16x32_bf16 v[12:15], v[16:19], v[60:63], v[12:15]
    ds_read_b64_tr_b16 v[88:89], v4 offset:32768
    ds_read_b64_tr_b16 v[90:91], v4 offset:33024
    s_waitcnt lgkmcnt(12)
    v_mfma_f32_16x16x32_bf16 v[8:11], v[64:67], v[64:67], v[8:11]
    v_mfma_f32_16x16x32_bf16 v[12:15], v[16:19], v[64:67], v[12:15]
    ds_read_b64_tr_b16 v[92:93], v4 offset:34816
    ds_read_b64_tr_b16 v[94:95], v4 offset:35072
    s_waitcnt lgkmcnt(12)
    v_mfma_f32_16x16x32_bf16 v[8:11], v[68:71], v[68:71], v[8:11]
    v_mfma_f32_16x16x32_bf16 v[12:15], v[16:19], v[68:71], v[12:15]
    s_waitcnt lgkmcnt(10)
    v_mfma_f32_16x16x32_bf16 v[8:11], v[72:75], v[72:75], v[8:11]
    v_mfma_f32_16x16x32_bf16 v[12:15], v[16:19], v[72:75], v[12:15]
    s_waitcnt lgkmcnt(8)
    v_mfma_f32_16x16x32_bf16 v[8:11], v[76:79], v[76:79], v[8:11]
    v_mfma_f32_16x16x32_bf16 v[12:15], v[16:19], v[76:79], v[12:15]
    s_waitcnt lgkmcnt(6)
    v_mfma_f32_16x16x32_bf16 v[8:11], v[80:83], v[80:83], v[8:11]
    v_mfma_f32_16x16x32_bf16 v[12:15], v[16:19], v[80:83], v[12:15]
    s_waitcnt lgkmcnt(4)
    v_mfma_f32_16x16x32_bf16 v[8:11], v[84:87], v[84:87], v[8:11]
    v_mfma_f32_16x16x32_bf16 v[12:15], v[16:19], v[84:87], v[12:15]
    s_waitcnt lgkmcnt(2)
    v_mfma_f32_16x16x32_bf16 v[8:11], v[88:91], v[88:91], v[8:11]
    v_mfma_f32_16x16x32_bf16 v[12:15], v[16:19], v[88:91], v[12:15]
    s_waitcnt lgkmcnt(0)
    v_mfma_f32_16x16x32_bf16 v[8:11], v[92:95], v[92:95], v[8:11]
    v_mfma_f32_16x16x32_bf16 v[12:15], v[16:19], v[92:95], v[12:15]
    s_nop 7
    v_and_b32 v25, 3, v3
    v_mov_b32 v24, v8
    v_cmp_eq_u32 vcc, 1, v25
    s_nop 1
    v_cndmask_b32 v24, v24, v9, vcc
    v_cmp_eq_u32 vcc, 2, v25
    s_nop 1
    v_cndmask_b32 v24, v24, v10, vcc
    v_cmp_eq_u32 vcc, 3, v25
    s_nop 1
    v_cndmask_b32 v24, v24, v11, vcc
    v_bfe_u32 v25, v3, 2, 2
    v_lshrrev_b32 v8, 4, v3
    v_cmp_eq_u32 s[28:29], v25, v8
    v_mul_f32 v26, 0x3ae38e39, v12
    v_mul_f32 v27, 0x3ae38e39, v24
    v_fma_f32 v27, -v26, v26, v27
    v_max_f32 v27, 0, v27
    v_cvt_pk_bf16_f32 v36, v26, v26
    v_and_b32 v36, 0xffff0000, v36
    v_cvt_pk_bf16_f32 v28, v27, v27
    v_and_b32 v28, 0xffff0000, v28
    v_add_f32 v28, 0x3727c5ac, v28
    v_cvt_pk_bf16_f32 v28, v28, v28
    v_and_b32 v28, 0xffff0000, v28
    v_sqrt_f32 v28, v28
    s_nop 0
    v_cvt_pk_bf16_f32 v28, v28, v28
    v_and_b32 v28, 0xffff0000, v28
    v_rcp_f32 v37, v28
    v_sub_f32 v29, v26, v36
    v_mul_f32 v29, v29, v37
    v_cvt_pk_bf16_f32 v29, v29, v29
    v_and_b32 v29, 0xffff0000, v29
    v_mul_f32 v27, v27, v37
    v_mul_f32 v27, v27, v37
    v_cvt_pk_bf16_f32 v35, v27, v27
    v_and_b32 v35, 0xffff0000, v35
    v_add_f32 v35, 0x3727c5ac, v35
    v_cvt_pk_bf16_f32 v35, v35, v35
    v_and_b32 v35, 0xffff0000, v35
    v_sqrt_f32 v35, v35
    s_nop 0
    v_cvt_pk_bf16_f32 v35, v35, v35
    v_and_b32 v35, 0xffff0000, v35
    v_fma_f32 v32, v29, v28, v36
    v_mul_f32 v35, v35, v28
    v_rcp_f32 v24, v35
    s_nop 0
    v_mul_f32 v33, 0xc0135761, v24
    v_mul_f32 v34, v24, v24
    v_mul_f32 v34, v34, v24
    v_mul_f32 v34, 0xbdd2d3e8, v34
    v_and_b32 v4, 15, v3
    s_lshl_b32 s16, s14, 9
    v_lshl_add_u32 v4, v4, 5, s16
    s_mov_b64 exec, s[28:29]
    ds_write_b128 v4, v[32:35] offset:36864
    ds_write_b64 v4, v[36:37] offset:36880
    s_mov_b64 exec, -1
    v_mov_b32 v40, 163388
    v_mov_b32 v41, 1
    s_mov_b64 exec, 1
    ds_add_u32 v40, v41
    s_mov_b64 exec, -1
    s_setprio 0
    s_cmp_eq_u32 s14, 0
    s_cbranch_scc1 km_kernel_d_pre
    v_mov_b32 v66, 163372
    s_mov_b32 s17, 262144
lw_74:
    ds_read_b32 v67, v66
    s_sub_u32 s17, s17, 1
    s_waitcnt lgkmcnt(0)
    v_readfirstlane_b32 s16, v67
    s_cmp_eq_u32 s17, 0
    s_cbranch_scc1 lwd_75
    s_cmp_ge_u32 s16, 9
    s_cbranch_scc1 lwd_75
    s_sleep 2
    s_branch lw_74
lwd_75:
    v_min_u32 v4, 53, v3
    s_mul_i32 s16, s12, 54
    s_add_u32 s16, s16, 162
    v_add_lshl_u32 v4, v4, s16, 7
    s_mov_b32 s16, 19464192
    s_mov_b32 s17, 32768
poll_76:
    buffer_load_dword v5, v4, s[8:11], s16 offen offset:0 sc1
    s_sub_u32 s17, s17, 1
    s_cmp_eq_u32 s17, 0
    s_waitcnt vmcnt(0)
    s_cbranch_scc1 pdone_77
    v_xor_b32 v5, s15, v5
    v_cmp_ne_u32 vcc, 0, v5
    s_nop 4
    s_cbranch_vccz pdone_77
    s_sleep 4
    s_branch poll_76
pdone_77:
    s_branch km_kernel_d_pre
km_kernel_c_hf:
    s_lshr_b32 s24, s21, 1
    s_lshl_b32 s25, s24, 11
    s_and_b32 s26, s21, 1
    s_lshl_b32 s16, s26, 5
    v_xor_b32 v6, s16, v5
    v_add_u32 v6, s25, v6
    ds_read_b64_tr_b16 v[48:49], v6 offset:0
    ds_read_b64_tr_b16 v[50:51], v6 offset:256
    ds_read_b64_tr_b16 v[52:53], v6 offset:4096
    ds_read_b64_tr_b16 v[54:55], v6 offset:4352
    ds_read_b64_tr_b16 v[56:57], v6 offset:8192
    ds_read_b64_tr_b16 v[58:59], v6 offset:8448
    ds_read_b64_tr_b16 v[60:61], v6 offset:12288
    ds_read_b64_tr_b16 v[62:63], v6 offset:12544
    ds_read_b64_tr_b16 v[64:65], v6 offset:16384
    ds_read_b64_tr_b16 v[66:67], v6 offset:16640
    ds_read_b64_tr_b16 v[68:69], v6 offset:20480
    ds_read_b64_tr_b16 v[70:71], v6 offset:20736
    ds_read_b64_tr_b16 v[72:73], v6 offset:24576
    ds_read_b64_tr_b16 v[74:75], v6 offset:24832
    ds_read_b64_tr_b16 v[76:77], v6 offset:28672
    ds_read_b64_tr_b16 v[78:79], v6 offset:28928
    ds_read_b64_tr_b16 v[80:81], v6 offset:32768
    ds_read_b64_tr_b16 v[82:83], v6 offset:33024
    s_lshl_b32 s25, s20, 1
    s_add_u32 s25, s25, s26
    s_mul_i32 s25, s25, 18
    s_add_u32 s25, s25, s24
    s_lshl_b32 s25, s25, 10
    s_add_u32 s25, s25, 7077888
    v_min_u32 v4, 11, v3
    s_lshl_b32 s16, s20, 2
    s_sub_u32 s16, s16, 4
    v_add_u32 v4, s16, v4
    v_and_b32 v4, 255, v4
    v_lshlrev_b32 v4, 7, v4
    v_mov_b32 v6, 163372
    s_mov_b32 s17, 262144
lw_78:
    ds_read_b32 v7, v6
    s_sub_u32 s17, s17, 1
    s_waitcnt lgkmcnt(0)
    v_readfirstlane_b32 s16, v7
    s_cmp_eq_u32 s17, 0
    s_cbranch_scc1 lwd_79
    s_cmp_ge_u32 s16, 9
    s_cbranch_scc1 lwd_79
    s_sleep 1
    s_branch lw_78
lwd_79:
    s_mov_b32 s16, 19300352
    s_mov_b32 s17, 32768
poll_80:
    buffer_load_dword v100, v4, s[8:11], s16 offen sc1
    s_sub_u32 s17, s17, 1
    s_cmp_eq_u32 s17, 0
    s_waitcnt vmcnt(0)
    s_cbranch_scc1 pdone_81
    v_xor_b32 v100, s15, v100
    v_cmp_ne_u32 vcc, 0, v100
    s_nop 4
    s_cbranch_vccz pdone_81
    s_sleep 1
    s_branch poll_80
pdone_81:
km_kernel_d_pre:
    s_mul_i32 s28, s20, 36864
    s_mul_i32 s16, s14, 3072
    s_add_u32 s24, s28, s16
    s_add_u32 s24, s24, 9437184
    v_add_u32 v4, s16, v1
    s_barrier
    buffer_load_dwordx4 v[32:35], v1, s[8:11], s24 offen offset:0 sc1
    buffer_load_dwordx4 v[36:39], v1, s[8:11], s24 offen offset:1024 sc1
    buffer_load_dwordx4 v[40:43], v1, s[8:11], s24 offen offset:2048 sc1
    s_waitcnt vmcnt(2)
    ds_write_b128 v4, v[32:35] offset:0
    s_waitcnt vmcnt(1)
    ds_write_b128 v4, v[36:39] offset:1024
    s_waitcnt vmcnt(0)
    ds_write_b128 v4, v[40:43] offset:2048
    s_waitcnt lgkmcnt(0)
    s_barrier
    s_cmp_lt_u32 s14, 3
    s_cbranch_scc1 km_kernel_d_aux
    s_setprio 1
    ds_read_b128 v[32:35], v5 offset:0
    ds_read_b128 v[36:39], v5 offset:18432
    ds_read_b128 v[40:43], v5 offset:1024
    ds_read_b128 v[44:47], v5 offset:19456
    ds_read_b128 v[84:87], v5 offset:2048
    ds_read_b128 v[88:91], v5 offset:20480
    ds_read_b128 v[92:95], v5 offset:3072
    ds_read_b128 v[96:99], v5 offset:21504
    ds_read_b128 v[100:103], v5 offset:4096
    ds_read_b128 v[104:107], v5 offset:22528
    ds_read_b128 v[108:111], v5 offset:5120
    ds_read_b128 v[112:115], v5 offset:23552
    s_waitcnt lgkmcnt(10)
    v_mfma_f32_16x16x32_bf16 v[16:19], v[136:139], v[32:35], v[16:19]
    v_mfma_f32_16x16x32_bf16 v[20:23], v[136:139], v[36:39], v[20:23]
    v_mfma_f32_16x16x32_bf16 v[24:27], v[140:143], v[32:35], v[24:27]
    v_mfma_f32_16x16x32_bf16 v[28:31], v[140:143], v[36:39], v[28:31]
    v_mfma_f32_16x16x32_bf16 v[8:11], v[132:135], v[32:35], v[8:11]
    v_mfma_f32_16x16x32_bf16 v[12:15], v[132:135], v[36:39], v[12:15]
    s_waitcnt lgkmcnt(8)
    v_mfma_f32_16x16x32_bf16 v[16:19], v[148:151], v[40:43], v[16:19]
    v_mfma_f32_16x16x32_bf16 v[20:23], v[148:151], v[44:47], v[20:23]
    v_mfma_f32_16x16x32_bf16 v[24:27], v[152:155], v[40:43], v[24:27]
    v_mfma_f32_16x16x32_bf16 v[28:31], v[152:155], v[44:47], v[28:31]
    v_mfma_f32_16x16x32_bf16 v[8:11], v[144:147], v[40:43], v[8:11]
    v_mfma_f32_16x16x32_bf16 v[12:15], v[144:147], v[44:47], v[12:15]
    s_waitcnt lgkmcnt(6)
    v_mfma_f32_16x16x32_bf16 v[16:19], v[160:163], v[84:87], v[16:19]
    v_mfma_f32_16x16x32_bf16 v[20:23], v[160:163], v[88:91], v[20:23]
    v_mfma_f32_16x16x32_bf16 v[24:27], v[164:167], v[84:87], v[24:27]
    v_mfma_f32_16x16x32_bf16 v[28:31], v[164:167], v[88:91], v[28:31]
    v_mfma_f32_16x16x32_bf16 v[8:11], v[156:159], v[84:87], v[8:11]
    v_mfma_f32_16x16x32_bf16 v[12:15], v[156:159], v[88:91], v[12:15]
    s_waitcnt lgkmcnt(4)
    v_mfma_f32_16x16x32_bf16 v[16:19], v[52:55], v[92:95], v[16:19]
    v_mfma_f32_16x16x32_bf16 v[20:23], v[52:55], v[96:99], v[20:23]
    v_mfma_f32_16x16x32_bf16 v[24:27], v[56:59], v[92:95], v[24:27]
    v_mfma_f32_16x16x32_bf16 v[28:31], v[56:59], v[96:99], v[28:31]
    v_mfma_f32_16x16x32_bf16 v[8:11], v[48:51], v[92:95], v[8:11]
    v_mfma_f32_16x16x32_bf16 v[12:15], v[48:51], v[96:99], v[12:15]
    s_waitcnt lgkmcnt(2)
    v_mfma_f32_16x16x32_bf16 v[16:19], v[64:67], v[100:103], v[16:19]
    v_mfma_f32_16x16x32_bf16 v[20:23], v[64:67], v[104:107], v[20:23]
    v_mfma_f32_16x16x32_bf16 v[24:27], v[68:71], v[100:103], v[24:27]
    v_mfma_f32_16x16x32_bf16 v[28:31], v[68:71], v[104:107], v[28:31]
    v_mfma_f32_16x16x32_bf16 v[8:11], v[60:63], v[100:103], v[8:11]
    v_mfma_f32_16x16x32_bf16 v[12:15], v[60:63], v[104:107], v[12:15]
    s_waitcnt lgkmcnt(0)
    v_mfma_f32_16x16x32_bf16 v[16:19], v[76:79], v[108:111], v[16:19]
    v_mfma_f32_16x16x32_bf16 v[20:23], v[76:79], v[112:115], v[20:23]
    v_mfma_f32_16x16x32_bf16 v[24:27], v[80:83], v[108:111], v[24:27]
    v_mfma_f32_16x16x32_bf16 v[28:31], v[80:83], v[112:115], v[28:31]
    v_mfma_f32_16x16x32_bf16 v[8:11], v[72:75], v[108:111], v[8:11]
    v_mfma_f32_16x16x32_bf16 v[12:15], v[72:75], v[112:115], v[12:15]
    s_nop 3
    ds_write_b128 v0, v[16:19] offset:0
    ds_write_b128 v0, v[20:23] offset:1024
    ds_write_b128 v120, v[24:27] offset:2048
    ds_write_b128 v120, v[28:31] offset:3072
    s_mov_b64 exec, 1
    ds_add_u32 v126, v127
    s_mov_b64 exec, -1
    s_setprio 0
    s_mov_b32 s17, 262144
xr_82:
    ds_read_b32 v4, v126
    ds_read_b128 v[16:19], v121 offset:0
    ds_read_b128 v[20:23], v121 offset:1024
    ds_read_b128 v[24:27], v121 offset:2048
    ds_read_b128 v[28:31], v121 offset:3072
    s_sub_u32 s17, s17, 1
    s_waitcnt lgkmcnt(0)
    s_cmp_eq_u32 s17, 0
    s_cbranch_scc1 xrd_83
    v_readfirstlane_b32 s16, v4
    s_nop 0
    s_cmp_eq_u32 s16, 3
    s_cbranch_scc1 xrd_83
    s_sleep 1
    s_branch xr_82
xrd_83:
    v_add_f32 v8, v8, v16
    v_add_f32 v9, v9, v17
    v_add_f32 v10, v10, v18
    v_add_f32 v11, v11, v19
    v_add_f32 v12, v12, v20
    v_add_f32 v13, v13, v21
    v_add_f32 v14, v14, v22
    v_add_f32 v15, v15, v23
    v_add_f32 v8, v8, v24
    v_add_f32 v9, v9, v25
    v_add_f32 v10, v10, v26
    v_add_f32 v11, v11, v27
    v_add_f32 v12, v12, v28
    v_add_f32 v13, v13, v29
    v_add_f32 v14, v14, v30
    v_add_f32 v15, v15, v31
    v_cvt_pk_bf16_f32 v8, v8, v9
    v_cvt_pk_bf16_f32 v9, v10, v11
    v_cvt_pk_bf16_f32 v10, v12, v13
    v_cvt_pk_bf16_f32 v11, v14, v15
    s_nop 1
    v_permlane16_swap_b32 v8, v10
    v_permlane16_swap_b32 v9, v11
    buffer_store_dwordx4 v[8:11], v122, s[8:11], s60 offen sc1
    v_mov_b32 v16, 0x3f803f80
    v_mov_b32 v18, 0
    v_mov_b32 v19, 0
    s_lshl_b32 s16, s22, 9
    s_add_u32 s16, s16, 152064
    v_lshl_add_u32 v17, v3, 3, s16
    v_dot2_f32_bf16 v18, v8, v16, v18
    v_dot2_f32_bf16 v19, v8, v8, v19
    v_dot2_f32_bf16 v18, v9, v16, v18
    v_dot2_f32_bf16 v19, v9, v9, v19
    v_dot2_f32_bf16 v18, v10, v16, v18
    v_dot2_f32_bf16 v19, v10, v10, v19
    v_dot2_f32_bf16 v18, v11, v16, v18
    v_dot2_f32_bf16 v19, v11, v11, v19
    s_nop 2
    ds_write_b64 v17, v[18:19]
    v_mov_b32 v20, 163512
    v_mov_b32 v21, 1
    s_mov_b64 exec, 1
    ds_add_u32 v20, v21
    s_mov_b64 exec, -1
    s_waitcnt vmcnt(0)
    v_mov_b32 v112, 163376
    v_mov_b32 v113, 1
    s_mov_b64 exec, 1
    ds_add_rtn_u32 v113, v112, v113
    s_waitcnt lgkmcnt(0)
    v_readfirstlane_b32 s16, v113
    v_mov_b32 v112, s15
    s_cmp_lg_u32 s16, 9
    s_cbranch_scc1 sig_84
    buffer_store_dword v112, off, s[8:11], s62 sc1
sig_84:
    s_mov_b64 exec, -1
    v_mov_b32 v112, 163376
    s_mov_b32 s17, 262144
lw_85:
    ds_read_b32 v113, v112
    s_sub_u32 s17, s17, 1
    s_waitcnt lgkmcnt(0)
    v_readfirstlane_b32 s16, v113
    s_cmp_eq_u32 s17, 0
    s_cbranch_scc1 lwd_86
    s_cmp_ge_u32 s16, 10
    s_cbranch_scc1 lwd_86
    s_sleep 2
    s_branch lw_85
lwd_86:
    s_branch km_kernel_e_pre
km_kernel_d_aux:
    s_cmp_lg_u32 s14, 2
    s_cbranch_scc1 km_kernel_e_pre
    buffer_store_dwordx4 v[48:51], v1, s[8:11], s25 offen offset:0 sc1
    buffer_store_dwordx4 v[52:55], v1, s[8:11], s25 offen offset:2048 sc1
    s_add_u32 s25, s25, 4096
    buffer_store_dwordx4 v[56:59], v1, s[8:11], s25 offen offset:0 sc1
    buffer_store_dwordx4 v[60:63], v1, s[8:11], s25 offen offset:2048 sc1
    s_add_u32 s25, s25, 4096
    buffer_store_dwordx4 v[64:67], v1, s[8:11], s25 offen offset:0 sc1
    buffer_store_dwordx4 v[68:71], v1, s[8:11], s25 offen offset:2048 sc1
    s_add_u32 s25, s25, 4096
    buffer_store_dwordx4 v[72:75], v1, s[8:11], s25 offen offset:0 sc1
    buffer_store_dwordx4 v[76:79], v1, s[8:11], s25 offen offset:2048 sc1
    s_add_u32 s25, s25, 4096
    buffer_store_dwordx4 v[80:83], v1, s[8:11], s25 offen offset:0 sc1
    s_waitcnt vmcnt(0)
    v_mov_b32 v108, 163376
    v_mov_b32 v109, 1
    s_mov_b64 exec, 1
    ds_add_rtn_u32 v109, v108, v109
    s_waitcnt lgkmcnt(0)
    v_readfirstlane_b32 s16, v109
    v_mov_b32 v108, s15
    s_cmp_lg_u32 s16, 9
    s_cbranch_scc1 sig_87
    buffer_store_dword v108, off, s[8:11], s27 sc1
sig_87:
    s_mov_b64 exec, -1
km_kernel_e_pre:
    s_mul_i32 s18, s12, 663552
    s_mul_i32 s19, s14, 55296
    s_add_u32 s18, s18, s19
    s_add_u32 s18, s18, 21250048
    s_add_u32 s19, s18, 5308416
    s_mul_i32 s20, s12, 2304
    s_add_u32 s20, s20, 19087360
    s_lshl_b32 s16, s14, 8
    v_lshl_add_u32 v4, v3, 2, s16
    buffer_load_dword v160, v4, s[8:11], s20 offen sc1
    s_add_u32 s20, s20, 18432
    buffer_load_dword v161, v4, s[8:11], s20 offen sc1
    s_add_u32 s20, s20, 18432
    buffer_load_dword v162, v4, s[8:11], s20 offen sc1
    s_setprio 2
    buffer_load_dwordx4 v[88:91], v1, s[8:11], s18 offen offset:0 sc1
    buffer_load_dwordx4 v[92:95], v1, s[8:11], s18 offen offset:1024 sc1
    buffer_load_dwordx4 v[96:99], v1, s[8:11], s18 offen offset:2048 sc1
    buffer_load_dwordx4 v[100:103], v1, s[8:11], s18 offen offset:3072 sc1
    s_add_u32 s18, s18, 4096
    buffer_load_dwordx4 v[104:107], v1, s[8:11], s18 offen offset:0 sc1
    buffer_load_dwordx4 v[108:111], v1, s[8:11], s18 offen offset:1024 sc1
    buffer_load_dwordx4 v[112:115], v1, s[8:11], s18 offen offset:2048 sc1
    buffer_load_dwordx4 v[116:119], v1, s[8:11], s18 offen offset:3072 sc1
    s_add_u32 s18, s18, 4096
    buffer_load_dwordx4 v[120:123], v1, s[8:11], s18 offen offset:0 sc1
    buffer_load_dwordx4 v[124:127], v1, s[8:11], s18 offen offset:1024 sc1
    buffer_load_dwordx4 v[128:131], v1, s[8:11], s18 offen offset:2048 sc1
    buffer_load_dwordx4 v[132:135], v1, s[8:11], s18 offen offset:3072 sc1
    s_add_u32 s18, s18, 4096
    buffer_load_dwordx4 v[136:139], v1, s[8:11], s18 offen offset:0 sc1
    buffer_load_dwordx4 v[140:143], v1, s[8:11], s18 offen offset:1024 sc1
    buffer_load_dwordx4 v[144:147], v1, s[8:11], s18 offen offset:2048 sc1
    buffer_load_dwordx4 v[148:151], v1, s[8:11], s18 offen offset:3072 sc1
    s_add_u32 s18, s18, 4096
    buffer_load_dwordx4 v[152:155], v1, s[8:11], s18 offen offset:0 sc1
    buffer_load_dwordx4 v[156:159], v1, s[8:11], s18 offen offset:1024 sc1
    s_add_u32 s18, s18, 2048
npf_88:
    s_cmp_lg_u32 s14, 1
    s_cbranch_scc1 sp_89
    v_mov_b32 v8, 163512
    s_mov_b32 s17, 262144
lw_90:
    ds_read_b32 v9, v8
    s_sub_u32 s17, s17, 1
    s_waitcnt lgkmcnt(0)
    v_readfirstlane_b32 s16, v9
    s_cmp_eq_u32 s17, 0
    s_cbranch_scc1 lwd_91
    s_cmp_ge_u32 s16, 9
    s_cbranch_scc1 lwd_91
    s_sleep 2
    s_branch lw_90
lwd_91:
    v_lshlrev_b32 v8, 3, v3
    v_add_u32 v8, 152064, v8
    ds_read_b64 v[10:11], v8 offset:0
    ds_read_b64 v[12:13], v8 offset:512
    ds_read_b64 v[14:15], v8 offset:1024
    ds_read_b64 v[16:17], v8 offset:1536
    ds_read_b64 v[18:19], v8 offset:2048
    ds_read_b64 v[20:21], v8 offset:2560
    ds_read_b64 v[22:23], v8 offset:3072
    ds_read_b64 v[24:25], v8 offset:3584
    ds_read_b64 v[26:27], v8 offset:4096
    s_waitcnt lgkmcnt(7)
    v_add_f32 v10, v10, v12
    v_add_f32 v11, v11, v13
    s_waitcnt lgkmcnt(6)
    v_add_f32 v10, v10, v14
    v_add_f32 v11, v11, v15
    s_waitcnt lgkmcnt(5)
    v_add_f32 v10, v10, v16
    v_add_f32 v11, v11, v17
    s_waitcnt lgkmcnt(4)
    v_add_f32 v10, v10, v18
    v_add_f32 v11, v11, v19
    s_waitcnt lgkmcnt(3)
    v_add_f32 v10, v10, v20
    v_add_f32 v11, v11, v21
    s_waitcnt lgkmcnt(2)
    v_add_f32 v10, v10, v22
    v_add_f32 v11, v11, v23
    s_waitcnt lgkmcnt(1)
    v_add_f32 v10, v10, v24
    v_add_f32 v11, v11, v25
    s_waitcnt lgkmcnt(0)
    v_add_f32 v10, v10, v26
    v_add_f32 v11, v11, v27
    v_mov_b32 v12, v10
    v_mov_b32 v13, v11
    s_nop 1
    v_permlane32_swap_b32 v10, v12
    v_permlane32_swap_b32 v11, v13
    v_add_f32 v28, v10, v12
    v_add_f32 v30, v11, v13
    v_mov_b32 v29, s15
    v_mov_b32 v31, s15
    s_sub_u32 s16, s27, 19333120
    s_lshl_b32 s16, s16, 2
    s_add_u32 s16, s16, 19595264
    s_mov_b32 exec_hi, 0
    buffer_store_dwordx4 v[28:31], v1, s[8:11], s16 offen sc1
    s_mov_b64 exec, -1
sp_89:
    s_cmp_lg_u32 s14, 2
    s_cbranch_scc1 km_kernel_e0
    v_min_u32 v5, 7, v3
    s_lshl_b32 s16, s13, 3
    v_add_lshl_u32 v5, v5, s16, 7
    s_mov_b32 s16, 19333120
    s_mov_b32 s17, 32768
poll_92:
    buffer_load_dword v164, v5, s[8:11], s16 offen sc1
    s_sub_u32 s17, s17, 1
    s_cmp_eq_u32 s17, 0
    s_waitcnt vmcnt(0)
    s_cbranch_scc1 pdone_93
    v_xor_b32 v164, s15, v164
    v_cmp_ne_u32 vcc, 0, v164
    s_nop 4
    s_cbranch_vccz pdone_93
    s_sleep 1
    s_branch poll_92
pdone_93:
    v_mov_b32 v6, 163376
    s_mov_b32 s17, 262144
lw_94:
    ds_read_b32 v7, v6
    s_sub_u32 s17, s17, 1
    s_waitcnt lgkmcnt(0)
    v_readfirstlane_b32 s16, v7
    s_cmp_eq_u32 s17, 0
    s_cbranch_scc1 lwd_95
    s_cmp_ge_u32 s16, 10
    s_cbranch_scc1 lwd_95
    s_sleep 1
    s_branch lw_94
lwd_95:
    v_mov_b32 v6, 163468
    v_mov_b32 v7, 1
    s_mov_b64 exec, 1
    ds_add_u32 v6, v7
    s_mov_b64 exec, -1
km_kernel_e0:
    s_mul_i32 s24, s13, 73728
    s_and_b32 s16, s14, 3
    s_mul_i32 s16, s16, 18432
    s_lshr_b32 s17, s14, 2
    s_mul_i32 s17, s17, 6144
    s_add_u32 s17, s17, s16
    s_add_u32 s16, s24, s17
    s_add_u32 s16, s16, 11796480
    v_add_u32 v5, s17, v1
    s_and_b32 s21, s14, 12
    s_add_u32 s21, s21, 163392
    v_mov_b32 v6, s21
    v_mov_b32 v7, 1
    s_mov_b32 s22, s16
    v_mov_b32 v84, 163468
    s_mov_b32 s17, 262144
lw_96:
    ds_read_b32 v85, v84
    s_sub_u32 s17, s17, 1
    s_waitcnt lgkmcnt(0)
    v_readfirstlane_b32 s16, v85
    s_cmp_eq_u32 s17, 0
    s_cbranch_scc1 lwd_97
    s_cmp_ge_u32 s16, 1
    s_cbranch_scc1 lwd_97
    s_sleep 1
    s_branch lw_96
lwd_97:
    s_mov_b32 s16, s22
    buffer_load_dwordx4 v[56:59], v1, s[8:11], s16 offen offset:0 sc1
    buffer_load_dwordx4 v[60:63], v1, s[8:11], s16 offen offset:1024 sc1
    buffer_load_dwordx4 v[64:67], v1, s[8:11], s16 offen offset:2048 sc1
    buffer_load_dwordx4 v[68:71], v1, s[8:11], s16 offen offset:3072 sc1
    s_add_u32 s16, s16, 4096
    buffer_load_dwordx4 v[72:75], v1, s[8:11], s16 offen offset:0 sc1
    buffer_load_dwordx4 v[76:79], v1, s[8:11], s16 offen offset:1024 sc1
    s_waitcnt vmcnt(6)
    v_add_f32 v160, v160, v161
    v_add_f32 v160, v160, v162
    s_cmp_ge_u32 s14, 9
    s_cbranch_scc1 ncs_98
    v_add_u32 v4, 147456, v4
    ds_write_b32 v4, v160
ncs_98:
    s_waitcnt vmcnt(5)
    ds_write_b128 v5, v[56:59] offset:0
    s_waitcnt vmcnt(4)
    ds_write_b128 v5, v[60:63] offset:1024
    s_waitcnt vmcnt(3)
    ds_write_b128 v5, v[64:67] offset:2048
    s_waitcnt vmcnt(2)
    ds_write_b128 v5, v[68:71] offset:3072
    s_waitcnt vmcnt(1)
    ds_write_b128 v5, v[72:75] offset:4096
    s_waitcnt vmcnt(0)
    ds_write_b128 v5, v[76:79] offset:5120
    s_mov_b64 exec, 1
    ds_add_u32 v6, v7
    s_mov_b64 exec, -1
    s_setprio 1
    s_cmp_lg_u32 s14, 8
    s_cbranch_scc1 km_kernel_nostat
    v_lshrrev_b32 v4, 5, v3
    v_and_b32 v5, 31, v3
    v_lshlrev_b32 v5, 4, v5
    v_lshl_add_u32 v4, v4, 11, v5
    s_lshl_b32 s22, s13, 12
    s_add_u32 s22, s22, 19595264
    s_mov_b32 s17, 32768
sp_99:
    buffer_load_dwordx4 v[64:67], v4, s[8:11], s22 offen offset:0 sc1
    buffer_load_dwordx4 v[68:71], v4, s[8:11], s22 offen offset:512 sc1
    buffer_load_dwordx4 v[72:75], v4, s[8:11], s22 offen offset:1024 sc1
    buffer_load_dwordx4 v[76:79], v4, s[8:11], s22 offen offset:1536 sc1
    s_sub_u32 s17, s17, 1
    s_cmp_eq_u32 s17, 0
    s_waitcnt vmcnt(0)
    s_cbranch_scc1 spd_100
    v_xor_b32 v5, s15, v65
    v_xor_b32 v6, s15, v67
    v_or_b32 v5, v5, v6
    v_xor_b32 v6, s15, v69
    v_or_b32 v5, v5, v6
    v_xor_b32 v6, s15, v71
    v_or_b32 v5, v5, v6
    v_xor_b32 v6, s15, v73
    v_or_b32 v5, v5, v6
    v_xor_b32 v6, s15, v75
    v_or_b32 v5, v5, v6
    v_xor_b32 v6, s15, v77
    v_or_b32 v5, v5, v6
    v_xor_b32 v6, s15, v79
    v_or_b32 v5, v5, v6
    v_cmp_ne_u32 vcc, 0, v5
    s_nop 4
    s_cbranch_vccz spd_100
    s_sleep 4
    s_branch sp_99
spd_100:
    v_add_f32 v64, v64, v68
    v_add_f32 v66, v66, v70
    v_add_f32 v64, v64, v72
    v_add_f32 v66, v66, v74
    v_add_f32 v64, v64, v76
    v_add_f32 v66, v66, v78
    v_mul_f32 v58, 0x3ae38e39, v64
    v_mul_f32 v59, 0x3ae38e39, v66
    v_fma_f32 v59, -v58, v58, v59
    v_max_f32 v59, 0, v59
    v_cvt_pk_bf16_f32 v60, v58, v58
    v_and_b32 v60, 0xffff0000, v60
    v_cvt_pk_bf16_f32 v63, v59, v59
    v_and_b32 v63, 0xffff0000, v63
    v_add_f32 v63, 0x3727c5ac, v63
    v_cvt_pk_bf16_f32 v63, v63, v63
    v_and_b32 v63, 0xffff0000, v63
    v_sqrt_f32 v63, v63
    s_nop 0
    v_cvt_pk_bf16_f32 v63, v63, v63
    v_and_b32 v63, 0xffff0000, v63
    v_rcp_f32 v56, v63
    s_nop 0
    v_mul_f32 v61, 0xc0135761, v56
    v_mul_f32 v62, v56, v56
    v_mul_f32 v62, v62, v56
    v_mul_f32 v62, 0xbdd2d3e8, v62
    v_add_u32 v57, 149760, v1
    ds_write_b128 v57, v[60:63]
    v_mov_b32 v160, 163380
    v_mov_b32 v161, 1
    s_mov_b64 exec, 1
    ds_add_u32 v160, v161
    s_mov_b64 exec, -1
    s_waitcnt lgkmcnt(0)
km_kernel_nostat:
    v_mov_b32 v2, v1
    s_mov_b32 s25, 0
    s_mov_b32 s27, 163392
    s_mov_b32 s28, 4
    s_cmp_lt_u32 s14, 0
    s_cselect_b32 s45, 2, 63
km_kernel_efirst:
    v_mov_b32 v160, s27
    s_mov_b32 s17, 262144
lw_101:
    ds_read_b32 v161, v160
    s_sub_u32 s17, s17, 1
    s_waitcnt lgkmcnt(0)
    v_readfirstlane_b32 s16, v161
    s_cmp_eq_u32 s17, 0
    s_cbranch_scc1 lwd_102
    s_cmp_ge_u32 s16, s28
    s_cbranch_scc1 lwd_102
    s_sleep 2
    s_branch lw_101
lwd_102:
    ds_read_b128 v[56:59], v2 offset:0
    ds_read_b128 v[72:75], v2 offset:1024
    ds_read_b128 v[60:63], v2 offset:18432
    ds_read_b128 v[76:79], v2 offset:19456
    ds_read_b128 v[64:67], v2 offset:36864
    ds_read_b128 v[80:83], v2 offset:37888
    ds_read_b128 v[68:71], v2 offset:55296
    ds_read_b128 v[84:87], v2 offset:56320
    s_add_u32 s46, s18, 3072
    s_waitcnt vmcnt(16) lgkmcnt(6)
    v_mfma_f32_16x16x32_bf16 v[8:11], v[88:91], v[56:59], 0
    v_mfma_f32_16x16x32_bf16 v[8:11], v[100:103], v[72:75], v[8:11]
    s_waitcnt vmcnt(14)
    v_mfma_f32_16x16x32_bf16 v[24:27], v[92:95], v[56:59], 0
    v_mfma_f32_16x16x32_bf16 v[24:27], v[104:107], v[72:75], v[24:27]
    s_waitcnt vmcnt(12)
    v_mfma_f32_16x16x32_bf16 v[40:43], v[96:99], v[56:59], 0
    v_mfma_f32_16x16x32_bf16 v[40:43], v[108:111], v[72:75], v[40:43]
    ds_read_b128 v[56:59], v2 offset:2048
    ds_read_b128 v[72:75], v2 offset:3072
    s_waitcnt lgkmcnt(6)
    v_mfma_f32_16x16x32_bf16 v[12:15], v[88:91], v[60:63], 0
    v_mfma_f32_16x16x32_bf16 v[12:15], v[100:103], v[76:79], v[12:15]
    v_mfma_f32_16x16x32_bf16 v[28:31], v[92:95], v[60:63], 0
    v_mfma_f32_16x16x32_bf16 v[28:31], v[104:107], v[76:79], v[28:31]
    v_mfma_f32_16x16x32_bf16 v[44:47], v[96:99], v[60:63], 0
    v_mfma_f32_16x16x32_bf16 v[44:47], v[108:111], v[76:79], v[44:47]
    ds_read_b128 v[60:63], v2 offset:20480
    ds_read_b128 v[76:79], v2 offset:21504
    s_waitcnt lgkmcnt(6)
    v_mfma_f32_16x16x32_bf16 v[16:19], v[88:91], v[64:67], 0
    v_mfma_f32_16x16x32_bf16 v[16:19], v[100:103], v[80:83], v[16:19]
    v_mfma_f32_16x16x32_bf16 v[32:35], v[92:95], v[64:67], 0
    v_mfma_f32_16x16x32_bf16 v[32:35], v[104:107], v[80:83], v[32:35]
    v_mfma_f32_16x16x32_bf16 v[48:51], v[96:99], v[64:67], 0
    v_mfma_f32_16x16x32_bf16 v[48:51], v[108:111], v[80:83], v[48:51]
    ds_read_b128 v[64:67], v2 offset:38912
    ds_read_b128 v[80:83], v2 offset:39936
    s_waitcnt lgkmcnt(6)
    v_mfma_f32_16x16x32_bf16 v[20:23], v[88:91], v[68:71], 0
    v_mfma_f32_16x16x32_bf16 v[20:23], v[100:103], v[84:87], v[20:23]
    buffer_load_dwordx4 v[88:91], v1, s[8:11], s18 offen offset:0 sc1
    buffer_load_dwordx4 v[100:103], v1, s[8:11], s46 offen offset:0 sc1
    v_mfma_f32_16x16x32_bf16 v[36:39], v[92:95], v[68:71], 0
    v_mfma_f32_16x16x32_bf16 v[36:39], v[104:107], v[84:87], v[36:39]
    buffer_load_dwordx4 v[92:95], v1, s[8:11], s18 offen offset:1024 sc1
    buffer_load_dwordx4 v[104:107], v1, s[8:11], s46 offen offset:1024 sc1
    v_mfma_f32_16x16x32_bf16 v[52:55], v[96:99], v[68:71], 0
    v_mfma_f32_16x16x32_bf16 v[52:55], v[108:111], v[84:87], v[52:55]
    buffer_load_dwordx4 v[96:99], v1, s[8:11], s18 offen offset:2048 sc1
    buffer_load_dwordx4 v[108:111], v1, s[8:11], s46 offen offset:2048 sc1
    ds_read_b128 v[68:71], v2 offset:57344
    ds_read_b128 v[84:87], v2 offset:58368
    s_add_u32 s18, s18, 6144
    s_branch km_kernel_ek1
km_kernel_eloop:
    v_mov_b32 v160, s27
    s_mov_b32 s17, 262144
lw_103:
    ds_read_b32 v161, v160
    s_sub_u32 s17, s17, 1
    s_waitcnt lgkmcnt(0)
    v_readfirstlane_b32 s16, v161
    s_cmp_eq_u32 s17, 0
    s_cbranch_scc1 lwd_104
    s_cmp_ge_u32 s16, s28
    s_cbranch_scc1 lwd_104
    s_sleep 2
    s_branch lw_103
lwd_104:
    ds_read_b128 v[56:59], v2 offset:0
    ds_read_b128 v[72:75], v2 offset:1024
    ds_read_b128 v[60:63], v2 offset:18432
    ds_read_b128 v[76:79], v2 offset:19456
    ds_read_b128 v[64:67], v2 offset:36864
    ds_read_b128 v[80:83], v2 offset:37888
    ds_read_b128 v[68:71], v2 offset:55296
    ds_read_b128 v[84:87], v2 offset:56320
km_kernel_ebody:
    s_cmp_eq_u32 s25, 5
    s_cbranch_scc1 km_kernel_elast
    s_add_u32 s46, s18, 3072
    s_waitcnt vmcnt(16) lgkmcnt(6)
    v_mfma_f32_16x16x32_bf16 v[8:11], v[88:91], v[56:59], v[8:11]
    v_mfma_f32_16x16x32_bf16 v[8:11], v[100:103], v[72:75], v[8:11]
    s_waitcnt vmcnt(14)
    v_mfma_f32_16x16x32_bf16 v[24:27], v[92:95], v[56:59], v[24:27]
    v_mfma_f32_16x16x32_bf16 v[24:27], v[104:107], v[72:75], v[24:27]
    s_waitcnt vmcnt(12)
    v_mfma_f32_16x16x32_bf16 v[40:43], v[96:99], v[56:59], v[40:43]
    v_mfma_f32_16x16x32_bf16 v[40:43], v[108:111], v[72:75], v[40:43]
    ds_read_b128 v[56:59], v2 offset:2048
    ds_read_b128 v[72:75], v2 offset:3072
    s_waitcnt lgkmcnt(6)
    v_mfma_f32_16x16x32_bf16 v[12:15], v[88:91], v[60:63], v[12:15]
    v_mfma_f32_16x16x32_bf16 v[12:15], v[100:103], v[76:79], v[12:15]
    v_mfma_f32_16x16x32_bf16 v[28:31], v[92:95], v[60:63], v[28:31]
    v_mfma_f32_16x16x32_bf16 v[28:31], v[104:107], v[76:79], v[28:31]
    v_mfma_f32_16x16x32_bf16 v[44:47], v[96:99], v[60:63], v[44:47]
    v_mfma_f32_16x16x32_bf16 v[44:47], v[108:111], v[76:79], v[44:47]
    ds_read_b128 v[60:63], v2 offset:20480
    ds_read_b128 v[76:79], v2 offset:21504
    s_waitcnt lgkmcnt(6)
    v_mfma_f32_16x16x32_bf16 v[16:19], v[88:91], v[64:67], v[16:19]
    v_mfma_f32_16x16x32_bf16 v[16:19], v[100:103], v[80:83], v[16:19]
    v_mfma_f32_16x16x32_bf16 v[32:35], v[92:95], v[64:67], v[32:35]
    v_mfma_f32_16x16x32_bf16 v[32:35], v[104:107], v[80:83], v[32:35]
    v_mfma_f32_16x16x32_bf16 v[48:51], v[96:99], v[64:67], v[48:51]
    v_mfma_f32_16x16x32_bf16 v[48:51], v[108:111], v[80:83], v[48:51]
    ds_read_b128 v[64:67], v2 offset:38912
    ds_read_b128 v[80:83], v2 offset:39936
    s_waitcnt lgkmcnt(6)
    v_mfma_f32_16x16x32_bf16 v[20:23], v[88:91], v[68:71], v[20:23]
    v_mfma_f32_16x16x32_bf16 v[20:23], v[100:103], v[84:87], v[20:23]
    buffer_load_dwordx4 v[88:91], v1, s[8:11], s18 offen offset:0 sc1
    buffer_load_dwordx4 v[100:103], v1, s[8:11], s46 offen offset:0 sc1
    v_mfma_f32_16x16x32_bf16 v[36:39], v[92:95], v[68:71], v[36:39]
    v_mfma_f32_16x16x32_bf16 v[36:39], v[104:107], v[84:87], v[36:39]
    buffer_load_dwordx4 v[92:95], v1, s[8:11], s18 offen offset:1024 sc1
    buffer_load_dwordx4 v[104:107], v1, s[8:11], s46 offen offset:1024 sc1
    v_mfma_f32_16x16x32_bf16 v[52:55], v[96:99], v[68:71], v[52:55]
    v_mfma_f32_16x16x32_bf16 v[52:55], v[108:111], v[84:87], v[52:55]
    buffer_load_dwordx4 v[96:99], v1, s[8:11], s18 offen offset:2048 sc1
    buffer_load_dwordx4 v[108:111], v1, s[8:11], s46 offen offset:2048 sc1
    ds_read_b128 v[68:71], v2 offset:57344
    ds_read_b128 v[84:87], v2 offset:58368
    s_add_u32 s18, s18, 6144
km_kernel_ek1:
    v_mov_b32 v160, s27
    s_add_u32 s46, s18, 3072
    s_waitcnt vmcnt(16) lgkmcnt(6)
    v_mfma_f32_16x16x32_bf16 v[8:11], v[112:115], v[56:59], v[8:11]
    v_mfma_f32_16x16x32_bf16 v[8:11], v[124:127], v[72:75], v[8:11]
    s_waitcnt vmcnt(14)
    v_mfma_f32_16x16x32_bf16 v[24:27], v[116:119], v[56:59], v[24:27]
    v_mfma_f32_16x16x32_bf16 v[24:27], v[128:131], v[72:75], v[24:27]
    s_waitcnt vmcnt(12)
    v_mfma_f32_16x16x32_bf16 v[40:43], v[120:123], v[56:59], v[40:43]
    v_mfma_f32_16x16x32_bf16 v[40:43], v[132:135], v[72:75], v[40:43]
    ds_read_b128 v[56:59], v2 offset:4096
    ds_read_b128 v[72:75], v2 offset:5120
    s_waitcnt lgkmcnt(6)
    v_mfma_f32_16x16x32_bf16 v[12:15], v[112:115], v[60:63], v[12:15]
    v_mfma_f32_16x16x32_bf16 v[12:15], v[124:127], v[76:79], v[12:15]
    v_mfma_f32_16x16x32_bf16 v[28:31], v[116:119], v[60:63], v[28:31]
    v_mfma_f32_16x16x32_bf16 v[28:31], v[128:131], v[76:79], v[28:31]
    v_mfma_f32_16x16x32_bf16 v[44:47], v[120:123], v[60:63], v[44:47]
    v_mfma_f32_16x16x32_bf16 v[44:47], v[132:135], v[76:79], v[44:47]
    ds_read_b128 v[60:63], v2 offset:22528
    ds_read_b128 v[76:79], v2 offset:23552
    s_waitcnt lgkmcnt(6)
    v_mfma_f32_16x16x32_bf16 v[16:19], v[112:115], v[64:67], v[16:19]
    v_mfma_f32_16x16x32_bf16 v[16:19], v[124:127], v[80:83], v[16:19]
    v_mfma_f32_16x16x32_bf16 v[32:35], v[116:119], v[64:67], v[32:35]
    v_mfma_f32_16x16x32_bf16 v[32:35], v[128:131], v[80:83], v[32:35]
    v_mfma_f32_16x16x32_bf16 v[48:51], v[120:123], v[64:67], v[48:51]
    v_mfma_f32_16x16x32_bf16 v[48:51], v[132:135], v[80:83], v[48:51]
    ds_read_b128 v[64:67], v2 offset:40960
    ds_read_b128 v[80:83], v2 offset:41984
    s_waitcnt lgkmcnt(6)
    v_mfma_f32_16x16x32_bf16 v[20:23], v[112:115], v[68:71], v[20:23]
    v_mfma_f32_16x16x32_bf16 v[20:23], v[124:127], v[84:87], v[20:23]
    buffer_load_dwordx4 v[112:115], v1, s[8:11], s18 offen offset:0 sc1
    buffer_load_dwordx4 v[124:127], v1, s[8:11], s46 offen offset:0 sc1
    v_mfma_f32_16x16x32_bf16 v[36:39], v[116:119], v[68:71], v[36:39]
    v_mfma_f32_16x16x32_bf16 v[36:39], v[128:131], v[84:87], v[36:39]
    buffer_load_dwordx4 v[116:119], v1, s[8:11], s18 offen offset:1024 sc1
    buffer_load_dwordx4 v[128:131], v1, s[8:11], s46 offen offset:1024 sc1
    v_mfma_f32_16x16x32_bf16 v[52:55], v[120:123], v[68:71], v[52:55]
    v_mfma_f32_16x16x32_bf16 v[52:55], v[132:135], v[84:87], v[52:55]
    buffer_load_dwordx4 v[120:123], v1, s[8:11], s18 offen offset:2048 sc1
    buffer_load_dwordx4 v[132:135], v1, s[8:11], s46 offen offset:2048 sc1
    ds_read_b128 v[68:71], v2 offset:59392
    ds_read_b128 v[84:87], v2 offset:60416
    s_add_u32 s18, s18, 6144
    ds_read_b32 v161, v160 offset:4
    s_add_u32 s46, s18, 3072
    s_waitcnt vmcnt(16) lgkmcnt(6)
    v_mfma_f32_16x16x32_bf16 v[8:11], v[136:139], v[56:59], v[8:11]
    v_mfma_f32_16x16x32_bf16 v[8:11], v[148:151], v[72:75], v[8:11]
    s_waitcnt vmcnt(14)
    v_mfma_f32_16x16x32_bf16 v[24:27], v[140:143], v[56:59], v[24:27]
    v_mfma_f32_16x16x32_bf16 v[24:27], v[152:155], v[72:75], v[24:27]
    s_waitcnt vmcnt(12)
    v_mfma_f32_16x16x32_bf16 v[40:43], v[144:147], v[56:59], v[40:43]
    v_mfma_f32_16x16x32_bf16 v[40:43], v[156:159], v[72:75], v[40:43]
    ds_read_b128 v[56:59], v2 offset:6144
    ds_read_b128 v[72:75], v2 offset:7168
    s_waitcnt lgkmcnt(6)
    v_mfma_f32_16x16x32_bf16 v[12:15], v[136:139], v[60:63], v[12:15]
    v_mfma_f32_16x16x32_bf16 v[12:15], v[148:151], v[76:79], v[12:15]
    v_mfma_f32_16x16x32_bf16 v[28:31], v[140:143], v[60:63], v[28:31]
    v_mfma_f32_16x16x32_bf16 v[28:31], v[152:155], v[76:79], v[28:31]
    v_mfma_f32_16x16x32_bf16 v[44:47], v[144:147], v[60:63], v[44:47]
    v_mfma_f32_16x16x32_bf16 v[44:47], v[156:159], v[76:79], v[44:47]
    ds_read_b128 v[60:63], v2 offset:24576
    ds_read_b128 v[76:79], v2 offset:25600
    s_waitcnt lgkmcnt(6)
    v_mfma_f32_16x16x32_bf16 v[16:19], v[136:139], v[64:67], v[16:19]
    v_mfma_f32_16x16x32_bf16 v[16:19], v[148:151], v[80:83], v[16:19]
    v_mfma_f32_16x16x32_bf16 v[32:35], v[140:143], v[64:67], v[32:35]
    v_mfma_f32_16x16x32_bf16 v[32:35], v[152:155], v[80:83], v[32:35]
    v_mfma_f32_16x16x32_bf16 v[48:51], v[144:147], v[64:67], v[48:51]
    v_mfma_f32_16x16x32_bf16 v[48:51], v[156:159], v[80:83], v[48:51]
    ds_read_b128 v[64:67], v2 offset:43008
    ds_read_b128 v[80:83], v2 offset:44032
    s_waitcnt lgkmcnt(6)
    v_mfma_f32_16x16x32_bf16 v[20:23], v[136:139], v[68:71], v[20:23]
    v_mfma_f32_16x16x32_bf16 v[20:23], v[148:151], v[84:87], v[20:23]
    buffer_load_dwordx4 v[136:139], v1, s[8:11], s18 offen offset:0 sc1
    buffer_load_dwordx4 v[148:151], v1, s[8:11], s46 offen offset:0 sc1
    v_mfma_f32_16x16x32_bf16 v[36:39], v[140:143], v[68:71], v[36:39]
    v_mfma_f32_16x16x32_bf16 v[36:39], v[152:155], v[84:87], v[36:39]
    buffer_load_dwordx4 v[140:143], v1, s[8:11], s18 offen offset:1024 sc1
    buffer_load_dwordx4 v[152:155], v1, s[8:11], s46 offen offset:1024 sc1
    v_mfma_f32_16x16x32_bf16 v[52:55], v[144:147], v[68:71], v[52:55]
    v_mfma_f32_16x16x32_bf16 v[52:55], v[156:159], v[84:87], v[52:55]
    buffer_load_dwordx4 v[144:147], v1, s[8:11], s18 offen offset:2048 sc1
    buffer_load_dwordx4 v[156:159], v1, s[8:11], s46 offen offset:2048 sc1
    ds_read_b128 v[68:71], v2 offset:61440
    ds_read_b128 v[84:87], v2 offset:62464
    s_add_u32 s18, s18, 6144
    v_add_u32 v2, 6144, v2
    s_add_u32 s25, s25, 1
    s_add_u32 s27, s27, 4
    s_cmp_eq_u32 s25, 5
    s_cselect_b32 s18, 0x10000000, s18
    s_cmp_eq_u32 s25, 6
    s_cbranch_scc1 km_kernel_efin
    s_cmp_eq_u32 s25, 3
    s_cbranch_scc1 km_kernel_egelu
    s_cmp_eq_u32 s25, 2
    s_cselect_b32 s18, s19, s18
    v_readfirstlane_b32 s16, v161
    s_cmp_lg_u32 s25, 5
    s_cbranch_scc1 n5_105
    v_mov_b32 v162, 163444
    v_mov_b32 v163, 1
    s_mov_b64 exec, 1
    ds_add_u32 v162, v163
    s_mov_b64 exec, -1
    s_waitcnt lgkmcnt(0)
n5_105:
    s_cmp_ge_u32 s16, s28
    s_cbranch_scc1 km_kernel_ebody
    s_branch km_kernel_eloop
km_kernel_egelu:
    v_mov_b32 v160, 163380
    s_mov_b32 s17, 262144
lw_106:
    ds_read_b32 v161, v160
    s_sub_u32 s17, s17, 1
    s_waitcnt lgkmcnt(0)
    v_readfirstlane_b32 s16, v161
    s_cmp_eq_u32 s17, 0
    s_cbranch_scc1 lwd_107
    s_cmp_ge_u32 s16, 1
    s_cbranch_scc1 lwd_107
    s_sleep 1
    s_branch lw_106
lwd_107:
    v_and_b32 v4, 15, v3
    v_lshlrev_b32 v4, 4, v4
    v_lshrrev_b32 v5, 4, v3
    v_add_u32 v6, 149760, v4
    ds_read_b128 v[56:59], v6 offset:0
    ds_read_b128 v[60:63], v6 offset:256
    ds_read_b128 v[64:67], v6 offset:512
    ds_read_b128 v[68:71], v6 offset:768
    s_mul_i32 s21, s14, 192
    s_add_u32 s21, s21, 147456
    v_lshl_add_u32 v6, v5, 4, s21
    ds_read_b128 v[72:75], v6 offset:0
    ds_read_b128 v[76:79], v6 offset:64
    ds_read_b128 v[80:83], v6 offset:128
    v_lshrrev_b32 v6, 1, v5
    v_lshl_add_u32 v4, v6, 8, v4
    v_and_b32 v6, 1, v5
    v_lshl_add_u32 v7, v6, 3, v4
    v_mul_u32_u24 v6, 18432, v6
    v_add_u32 v4, v4, v6
    s_mul_i32 s21, s14, 1536
    s_add_u32 s26, s21, 73728
    v_add_u32 v7, s26, v7
    s_waitcnt lgkmcnt(0)
    v_fma_f32 v8, -v56, v72, v8
    v_fma_f32 v9, -v56, v73, v9
    v_fma_f32 v10, -v56, v74, v10
    v_fma_f32 v11, -v56, v75, v11
    v_mul_f32 v160, v8, v8
    v_mul_f32 v161, v9, v9
    v_mul_f32 v162, v10, v10
    v_mul_f32 v163, v11, v11
    v_fma_f32 v160, v160, v58, v57
    v_fma_f32 v161, v161, v58, v57
    v_fma_f32 v162, v162, v58, v57
    v_fma_f32 v163, v163, v58, v57
    v_mul_f32 v160, v8, v160
    v_mul_f32 v161, v9, v161
    v_mul_f32 v162, v10, v162
    v_mul_f32 v163, v11, v163
    v_exp_f32 v160, v160
    v_exp_f32 v161, v161
    v_exp_f32 v162, v162
    v_exp_f32 v163, v163
    v_fma_f32 v160, v160, v59, v59
    v_fma_f32 v161, v161, v59, v59
    v_fma_f32 v162, v162, v59, v59
    v_fma_f32 v163, v163, v59, v59
    v_rcp_f32 v160, v160
    v_rcp_f32 v161, v161
    v_rcp_f32 v162, v162
    v_rcp_f32 v163, v163
    v_mul_f32 v8, v8, v160
    v_mul_f32 v9, v9, v161
    v_mul_f32 v10, v10, v162
    v_mul_f32 v11, v11, v163
    v_cvt_pk_bf16_f32 v164, v8, v9
    v_cvt_pk_bf16_f32 v165, v10, v11
    ds_write_b64 v7, v[164:165] offset:0
    v_fma_f32 v12, -v60, v72, v12
    v_fma_f32 v13, -v60, v73, v13
    v_fma_f32 v14, -v60, v74, v14
    v_fma_f32 v15, -v60, v75, v15
    v_mul_f32 v160, v12, v12
    v_mul_f32 v161, v13, v13
    v_mul_f32 v162, v14, v14
    v_mul_f32 v163, v15, v15
    v_fma_f32 v160, v160, v62, v61
    v_fma_f32 v161, v161, v62, v61
    v_fma_f32 v162, v162, v62, v61
    v_fma_f32 v163, v163, v62, v61
    v_mul_f32 v160, v12, v160
    v_mul_f32 v161, v13, v161
    v_mul_f32 v162, v14, v162
    v_mul_f32 v163, v15, v163
    v_exp_f32 v160, v160
    v_exp_f32 v161, v161
    v_exp_f32 v162, v162
    v_exp_f32 v163, v163
    v_fma_f32 v160, v160, v63, v63
    v_fma_f32 v161, v161, v63, v63
    v_fma_f32 v162, v162, v63, v63
    v_fma_f32 v163, v163, v63, v63
    v_rcp_f32 v160, v160
    v_rcp_f32 v161, v161
    v_rcp_f32 v162, v162
    v_rcp_f32 v163, v163
    v_mul_f32 v12, v12, v160
    v_mul_f32 v13, v13, v161
    v_mul_f32 v14, v14, v162
    v_mul_f32 v15, v15, v163
    v_cvt_pk_bf16_f32 v166, v12, v13
    v_cvt_pk_bf16_f32 v167, v14, v15
    ds_write_b64 v7, v[166:167] offset:18432
    v_fma_f32 v16, -v64, v72, v16
    v_fma_f32 v17, -v64, v73, v17
    v_fma_f32 v18, -v64, v74, v18
    v_fma_f32 v19, -v64, v75, v19
    v_mul_f32 v160, v16, v16
    v_mul_f32 v161, v17, v17
    v_mul_f32 v162, v18, v18
    v_mul_f32 v163, v19, v19
    v_fma_f32 v160, v160, v66, v65
    v_fma_f32 v161, v161, v66, v65
    v_fma_f32 v162, v162, v66, v65
    v_fma_f32 v163, v163, v66, v65
    v_mul_f32 v160, v16, v160
    v_mul_f32 v161, v17, v161
    v_mul_f32 v162, v18, v162
    v_mul_f32 v163, v19, v163
    v_exp_f32 v160, v160
    v_exp_f32 v161, v161
    v_exp_f32 v162, v162
    v_exp_f32 v163, v163
    v_fma_f32 v160, v160, v67, v67
    v_fma_f32 v161, v161, v67, v67
    v_fma_f32 v162, v162, v67, v67
    v_fma_f32 v163, v163, v67, v67
    v_rcp_f32 v160, v160
    v_rcp_f32 v161, v161
    v_rcp_f32 v162, v162
    v_rcp_f32 v163, v163
    v_mul_f32 v16, v16, v160
    v_mul_f32 v17, v17, v161
    v_mul_f32 v18, v18, v162
    v_mul_f32 v19, v19, v163
    v_cvt_pk_bf16_f32 v164, v16, v17
    v_cvt_pk_bf16_f32 v165, v18, v19
    ds_write_b64 v7, v[164:165] offset:36864
    v_fma_f32 v20, -v68, v72, v20
    v_fma_f32 v21, -v68, v73, v21
    v_fma_f32 v22, -v68, v74, v22
    v_fma_f32 v23, -v68, v75, v23
    v_mul_f32 v160, v20, v20
    v_mul_f32 v161, v21, v21
    v_mul_f32 v162, v22, v22
    v_mul_f32 v163, v23, v23
    v_fma_f32 v160, v160, v70, v69
    v_fma_f32 v161, v161, v70, v69
    v_fma_f32 v162, v162, v70, v69
    v_fma_f32 v163, v163, v70, v69
    v_mul_f32 v160, v20, v160
    v_mul_f32 v161, v21, v161
    v_mul_f32 v162, v22, v162
    v_mul_f32 v163, v23, v163
    v_exp_f32 v160, v160
    v_exp_f32 v161, v161
    v_exp_f32 v162, v162
    v_exp_f32 v163, v163
    v_fma_f32 v160, v160, v71, v71
    v_fma_f32 v161, v161, v71, v71
    v_fma_f32 v162, v162, v71, v71
    v_fma_f32 v163, v163, v71, v71
    v_rcp_f32 v160, v160
    v_rcp_f32 v161, v161
    v_rcp_f32 v162, v162
    v_rcp_f32 v163, v163
    v_mul_f32 v20, v20, v160
    v_mul_f32 v21, v21, v161
    v_mul_f32 v22, v22, v162
    v_mul_f32 v23, v23, v163
    v_cvt_pk_bf16_f32 v166, v20, v21
    v_cvt_pk_bf16_f32 v167, v22, v23
    ds_write_b64 v7, v[166:167] offset:55296
    v_fma_f32 v24, -v56, v76, v24
    v_fma_f32 v25, -v56, v77, v25
    v_fma_f32 v26, -v56, v78, v26
    v_fma_f32 v27, -v56, v79, v27
    v_mul_f32 v160, v24, v24
    v_mul_f32 v161, v25, v25
    v_mul_f32 v162, v26, v26
    v_mul_f32 v163, v27, v27
    v_fma_f32 v160, v160, v58, v57
    v_fma_f32 v161, v161, v58, v57
    v_fma_f32 v162, v162, v58, v57
    v_fma_f32 v163, v163, v58, v57
    v_mul_f32 v160, v24, v160
    v_mul_f32 v161, v25, v161
    v_mul_f32 v162, v26, v162
    v_mul_f32 v163, v27, v163
    v_exp_f32 v160, v160
    v_exp_f32 v161, v161
    v_exp_f32 v162, v162
    v_exp_f32 v163, v163
    v_fma_f32 v160, v160, v59, v59
    v_fma_f32 v161, v161, v59, v59
    v_fma_f32 v162, v162, v59, v59
    v_fma_f32 v163, v163, v59, v59
    v_rcp_f32 v160, v160
    v_rcp_f32 v161, v161
    v_rcp_f32 v162, v162
    v_rcp_f32 v163, v163
    v_mul_f32 v24, v24, v160
    v_mul_f32 v25, v25, v161
    v_mul_f32 v26, v26, v162
    v_mul_f32 v27, v27, v163
    v_cvt_pk_bf16_f32 v164, v24, v25
    v_cvt_pk_bf16_f32 v165, v26, v27
    ds_write_b64 v7, v[164:165] offset:512
    v_fma_f32 v28, -v60, v76, v28
    v_fma_f32 v29, -v60, v77, v29
    v_fma_f32 v30, -v60, v78, v30
    v_fma_f32 v31, -v60, v79, v31
    v_mul_f32 v160, v28, v28
    v_mul_f32 v161, v29, v29
    v_mul_f32 v162, v30, v30
    v_mul_f32 v163, v31, v31
    v_fma_f32 v160, v160, v62, v61
    v_fma_f32 v161, v161, v62, v61
    v_fma_f32 v162, v162, v62, v61
    v_fma_f32 v163, v163, v62, v61
    v_mul_f32 v160, v28, v160
    v_mul_f32 v161, v29, v161
    v_mul_f32 v162, v30, v162
    v_mul_f32 v163, v31, v163
    v_exp_f32 v160, v160
    v_exp_f32 v161, v161
    v_exp_f32 v162, v162
    v_exp_f32 v163, v163
    v_fma_f32 v160, v160, v63, v63
    v_fma_f32 v161, v161, v63, v63
    v_fma_f32 v162, v162, v63, v63
    v_fma_f32 v163, v163, v63, v63
    v_rcp_f32 v160, v160
    v_rcp_f32 v161, v161
    v_rcp_f32 v162, v162
    v_rcp_f32 v163, v163
    v_mul_f32 v28, v28, v160
    v_mul_f32 v29, v29, v161
    v_mul_f32 v30, v30, v162
    v_mul_f32 v31, v31, v163
    v_cvt_pk_bf16_f32 v166, v28, v29
    v_cvt_pk_bf16_f32 v167, v30, v31
    ds_write_b64 v7, v[166:167] offset:18944
    v_fma_f32 v32, -v64, v76, v32
    v_fma_f32 v33, -v64, v77, v33
    v_fma_f32 v34, -v64, v78, v34
    v_fma_f32 v35, -v64, v79, v35
    v_mul_f32 v160, v32, v32
    v_mul_f32 v161, v33, v33
    v_mul_f32 v162, v34, v34
    v_mul_f32 v163, v35, v35
    v_fma_f32 v160, v160, v66, v65
    v_fma_f32 v161, v161, v66, v65
    v_fma_f32 v162, v162, v66, v65
    v_fma_f32 v163, v163, v66, v65
    v_mul_f32 v160, v32, v160
    v_mul_f32 v161, v33, v161
    v_mul_f32 v162, v34, v162
    v_mul_f32 v163, v35, v163
    v_exp_f32 v160, v160
    v_exp_f32 v161, v161
    v_exp_f32 v162, v162
    v_exp_f32 v163, v163
    v_fma_f32 v160, v160, v67, v67
    v_fma_f32 v161, v161, v67, v67
    v_fma_f32 v162, v162, v67, v67
    v_fma_f32 v163, v163, v67, v67
    v_rcp_f32 v160, v160
    v_rcp_f32 v161, v161
    v_rcp_f32 v162, v162
    v_rcp_f32 v163, v163
    v_mul_f32 v32, v32, v160
    v_mul_f32 v33, v33, v161
    v_mul_f32 v34, v34, v162
    v_mul_f32 v35, v35, v163
    v_cvt_pk_bf16_f32 v164, v32, v33
    v_cvt_pk_bf16_f32 v165, v34, v35
    ds_write_b64 v7, v[164:165] offset:37376
    v_fma_f32 v36, -v68, v76, v36
    v_fma_f32 v37, -v68, v77, v37
    v_fma_f32 v38, -v68, v78, v38
    v_fma_f32 v39, -v68, v79, v39
    v_mul_f32 v160, v36, v36
    v_mul_f32 v161, v37, v37
    v_mul_f32 v162, v38, v38
    v_mul_f32 v163, v39, v39
    v_fma_f32 v160, v160, v70, v69
    v_fma_f32 v161, v161, v70, v69
    v_fma_f32 v162, v162, v70, v69
    v_fma_f32 v163, v163, v70, v69
    v_mul_f32 v160, v36, v160
    v_mul_f32 v161, v37, v161
    v_mul_f32 v162, v38, v162
    v_mul_f32 v163, v39, v163
    v_exp_f32 v160, v160
    v_exp_f32 v161, v161
    v_exp_f32 v162, v162
    v_exp_f32 v163, v163
    v_fma_f32 v160, v160, v71, v71
    v_fma_f32 v161, v161, v71, v71
    v_fma_f32 v162, v162, v71, v71
    v_fma_f32 v163, v163, v71, v71
    v_rcp_f32 v160, v160
    v_rcp_f32 v161, v161
    v_rcp_f32 v162, v162
    v_rcp_f32 v163, v163
    v_mul_f32 v36, v36, v160
    v_mul_f32 v37, v37, v161
    v_mul_f32 v38, v38, v162
    v_mul_f32 v39, v39, v163
    v_cvt_pk_bf16_f32 v166, v36, v37
    v_cvt_pk_bf16_f32 v167, v38, v39
    ds_write_b64 v7, v[166:167] offset:55808
    v_fma_f32 v40, -v56, v80, v40
    v_fma_f32 v41, -v56, v81, v41
    v_fma_f32 v42, -v56, v82, v42
    v_fma_f32 v43, -v56, v83, v43
    v_mul_f32 v160, v40, v40
    v_mul_f32 v161, v41, v41
    v_mul_f32 v162, v42, v42
    v_mul_f32 v163, v43, v43
    v_fma_f32 v160, v160, v58, v57
    v_fma_f32 v161, v161, v58, v57
    v_fma_f32 v162, v162, v58, v57
    v_fma_f32 v163, v163, v58, v57
    v_mul_f32 v160, v40, v160
    v_mul_f32 v161, v41, v161
    v_mul_f32 v162, v42, v162
    v_mul_f32 v163, v43, v163
    v_exp_f32 v160, v160
    v_exp_f32 v161, v161
    v_exp_f32 v162, v162
    v_exp_f32 v163, v163
    v_fma_f32 v160, v160, v59, v59
    v_fma_f32 v161, v161, v59, v59
    v_fma_f32 v162, v162, v59, v59
    v_fma_f32 v163, v163, v59, v59
    v_rcp_f32 v160, v160
    v_rcp_f32 v161, v161
    v_rcp_f32 v162, v162
    v_rcp_f32 v163, v163
    v_mul_f32 v40, v40, v160
    v_mul_f32 v41, v41, v161
    v_mul_f32 v42, v42, v162
    v_mul_f32 v43, v43, v163
    v_cvt_pk_bf16_f32 v164, v40, v41
    v_cvt_pk_bf16_f32 v165, v42, v43
    ds_write_b64 v7, v[164:165] offset:1024
    v_fma_f32 v44, -v60, v80, v44
    v_fma_f32 v45, -v60, v81, v45
    v_fma_f32 v46, -v60, v82, v46
    v_fma_f32 v47, -v60, v83, v47
    v_mul_f32 v160, v44, v44
    v_mul_f32 v161, v45, v45
    v_mul_f32 v162, v46, v46
    v_mul_f32 v163, v47, v47
    v_fma_f32 v160, v160, v62, v61
    v_fma_f32 v161, v161, v62, v61
    v_fma_f32 v162, v162, v62, v61
    v_fma_f32 v163, v163, v62, v61
    v_mul_f32 v160, v44, v160
    v_mul_f32 v161, v45, v161
    v_mul_f32 v162, v46, v162
    v_mul_f32 v163, v47, v163
    v_exp_f32 v160, v160
    v_exp_f32 v161, v161
    v_exp_f32 v162, v162
    v_exp_f32 v163, v163
    v_fma_f32 v160, v160, v63, v63
    v_fma_f32 v161, v161, v63, v63
    v_fma_f32 v162, v162, v63, v63
    v_fma_f32 v163, v163, v63, v63
    v_rcp_f32 v160, v160
    v_rcp_f32 v161, v161
    v_rcp_f32 v162, v162
    v_rcp_f32 v163, v163
    v_mul_f32 v44, v44, v160
    v_mul_f32 v45, v45, v161
    v_mul_f32 v46, v46, v162
    v_mul_f32 v47, v47, v163
    v_cvt_pk_bf16_f32 v166, v44, v45
    v_cvt_pk_bf16_f32 v167, v46, v47
    ds_write_b64 v7, v[166:167] offset:19456
    v_fma_f32 v48, -v64, v80, v48
    v_fma_f32 v49, -v64, v81, v49
    v_fma_f32 v50, -v64, v82, v50
    v_fma_f32 v51, -v64, v83, v51
    v_mul_f32 v160, v48, v48
    v_mul_f32 v161, v49, v49
    v_mul_f32 v162, v50, v50
    v_mul_f32 v163, v51, v51
    v_fma_f32 v160, v160, v66, v65
    v_fma_f32 v161, v161, v66, v65
    v_fma_f32 v162, v162, v66, v65
    v_fma_f32 v163, v163, v66, v65
    v_mul_f32 v160, v48, v160
    v_mul_f32 v161, v49, v161
    v_mul_f32 v162, v50, v162
    v_mul_f32 v163, v51, v163
    v_exp_f32 v160, v160
    v_exp_f32 v161, v161
    v_exp_f32 v162, v162
    v_exp_f32 v163, v163
    v_fma_f32 v160, v160, v67, v67
    v_fma_f32 v161, v161, v67, v67
    v_fma_f32 v162, v162, v67, v67
    v_fma_f32 v163, v163, v67, v67
    v_rcp_f32 v160, v160
    v_rcp_f32 v161, v161
    v_rcp_f32 v162, v162
    v_rcp_f32 v163, v163
    v_mul_f32 v48, v48, v160
    v_mul_f32 v49, v49, v161
    v_mul_f32 v50, v50, v162
    v_mul_f32 v51, v51, v163
    v_cvt_pk_bf16_f32 v164, v48, v49
    v_cvt_pk_bf16_f32 v165, v50, v51
    ds_write_b64 v7, v[164:165] offset:37888
    v_fma_f32 v52, -v68, v80, v52
    v_fma_f32 v53, -v68, v81, v53
    v_fma_f32 v54, -v68, v82, v54
    v_fma_f32 v55, -v68, v83, v55
    v_mul_f32 v160, v52, v52
    v_mul_f32 v161, v53, v53
    v_mul_f32 v162, v54, v54
    v_mul_f32 v163, v55, v55
    v_fma_f32 v160, v160, v70, v69
    v_fma_f32 v161, v161, v70, v69
    v_fma_f32 v162, v162, v70, v69
    v_fma_f32 v163, v163, v70, v69
    v_mul_f32 v160, v52, v160
    v_mul_f32 v161, v53, v161
    v_mul_f32 v162, v54, v162
    v_mul_f32 v163, v55, v163
    v_exp_f32 v160, v160
    v_exp_f32 v161, v161
    v_exp_f32 v162, v162
    v_exp_f32 v163, v163
    v_fma_f32 v160, v160, v71, v71
    v_fma_f32 v161, v161, v71, v71
    v_fma_f32 v162, v162, v71, v71
    v_fma_f32 v163, v163, v71, v71
    v_rcp_f32 v160, v160
    v_rcp_f32 v161, v161
    v_rcp_f32 v162, v162
    v_rcp_f32 v163, v163
    v_mul_f32 v52, v52, v160
    v_mul_f32 v53, v53, v161
    v_mul_f32 v54, v54, v162
    v_mul_f32 v55, v55, v163
    v_cvt_pk_bf16_f32 v166, v52, v53
    v_cvt_pk_bf16_f32 v167, v54, v55
    ds_write_b64 v7, v[166:167] offset:56320
    s_and_b32 s16, s14, 12
    s_add_u32 s16, s16, 163408
    v_mov_b32 v160, s16
    v_mov_b32 v161, 1
    s_mov_b64 exec, 1
    ds_add_u32 v160, v161
    s_mov_b64 exec, -1
    s_cmp_lg_u32 s45, 2
    s_cbranch_scc1 df_108
    buffer_load_dwordx4 v[88:91], v1, s[8:11], s18 offen offset:0 sc1
    buffer_load_dwordx4 v[92:95], v1, s[8:11], s18 offen offset:1024 sc1
    buffer_load_dwordx4 v[96:99], v1, s[8:11], s18 offen offset:2048 sc1
    buffer_load_dwordx4 v[100:103], v1, s[8:11], s18 offen offset:3072 sc1
    s_add_u32 s18, s18, 4096
    buffer_load_dwordx4 v[104:107], v1, s[8:11], s18 offen offset:0 sc1
    buffer_load_dwordx4 v[108:111], v1, s[8:11], s18 offen offset:1024 sc1
    buffer_load_dwordx4 v[112:115], v1, s[8:11], s18 offen offset:2048 sc1
    buffer_load_dwordx4 v[116:119], v1, s[8:11], s18 offen offset:3072 sc1
    s_add_u32 s18, s18, 4096
    buffer_load_dwordx4 v[120:123], v1, s[8:11], s18 offen offset:0 sc1
    buffer_load_dwordx4 v[124:127], v1, s[8:11], s18 offen offset:1024 sc1
    buffer_load_dwordx4 v[128:131], v1, s[8:11], s18 offen offset:2048 sc1
    buffer_load_dwordx4 v[132:135], v1, s[8:11], s18 offen offset:3072 sc1
    s_add_u32 s18, s18, 4096
    buffer_load_dwordx4 v[136:139], v1, s[8:11], s18 offen offset:0 sc1
    buffer_load_dwordx4 v[140:143], v1, s[8:11], s18 offen offset:1024 sc1
    buffer_load_dwordx4 v[144:147], v1, s[8:11], s18 offen offset:2048 sc1
    buffer_load_dwordx4 v[148:151], v1, s[8:11], s18 offen offset:3072 sc1
    s_add_u32 s18, s18, 4096
    buffer_load_dwordx4 v[152:155], v1, s[8:11], s18 offen offset:0 sc1
    buffer_load_dwordx4 v[156:159], v1, s[8:11], s18 offen offset:1024 sc1
    s_add_u32 s18, s18, 2048
df_108:
    s_setprio 0
    v_add_u32 v2, 73728, v1
    s_mov_b32 s27, 163408
    s_mov_b32 s28, 4
    s_branch km_kernel_efirst
km_kernel_elast:
    s_waitcnt vmcnt(16) lgkmcnt(6)
    v_mfma_f32_16x16x32_bf16 v[8:11], v[88:91], v[56:59], v[8:11]
    v_mfma_f32_16x16x32_bf16 v[8:11], v[100:103], v[72:75], v[8:11]
    s_waitcnt vmcnt(14)
    v_mfma_f32_16x16x32_bf16 v[24:27], v[92:95], v[56:59], v[24:27]
    v_mfma_f32_16x16x32_bf16 v[24:27], v[104:107], v[72:75], v[24:27]
    s_waitcnt vmcnt(12)
    v_mfma_f32_16x16x32_bf16 v[40:43], v[96:99], v[56:59], v[40:43]
    v_mfma_f32_16x16x32_bf16 v[40:43], v[108:111], v[72:75], v[40:43]
    ds_read_b128 v[56:59], v2 offset:2048
    ds_read_b128 v[72:75], v2 offset:3072
    s_waitcnt lgkmcnt(6)
    v_mfma_f32_16x16x32_bf16 v[12:15], v[88:91], v[60:63], v[12:15]
    v_mfma_f32_16x16x32_bf16 v[12:15], v[100:103], v[76:79], v[12:15]
    v_mfma_f32_16x16x32_bf16 v[28:31], v[92:95], v[60:63], v[28:31]
    v_mfma_f32_16x16x32_bf16 v[28:31], v[104:107], v[76:79], v[28:31]
    v_mfma_f32_16x16x32_bf16 v[44:47], v[96:99], v[60:63], v[44:47]
    v_mfma_f32_16x16x32_bf16 v[44:47], v[108:111], v[76:79], v[44:47]
    ds_read_b128 v[60:63], v2 offset:20480
    ds_read_b128 v[76:79], v2 offset:21504
    s_waitcnt lgkmcnt(6)
    v_mfma_f32_16x16x32_bf16 v[16:19], v[88:91], v[64:67], v[16:19]
    v_mfma_f32_16x16x32_bf16 v[16:19], v[100:103], v[80:83], v[16:19]
    v_mfma_f32_16x16x32_bf16 v[32:35], v[92:95], v[64:67], v[32:35]
    v_mfma_f32_16x16x32_bf16 v[32:35], v[104:107], v[80:83], v[32:35]
    v_mfma_f32_16x16x32_bf16 v[48:51], v[96:99], v[64:67], v[48:51]
    v_mfma_f32_16x16x32_bf16 v[48:51], v[108:111], v[80:83], v[48:51]
    ds_read_b128 v[64:67], v2 offset:38912
    ds_read_b128 v[80:83], v2 offset:39936
    s_waitcnt lgkmcnt(6)
    v_mfma_f32_16x16x32_bf16 v[20:23], v[88:91], v[68:71], v[20:23]
    v_mfma_f32_16x16x32_bf16 v[20:23], v[100:103], v[84:87], v[20:23]
    v_mfma_f32_16x16x32_bf16 v[36:39], v[92:95], v[68:71], v[36:39]
    v_mfma_f32_16x16x32_bf16 v[36:39], v[104:107], v[84:87], v[36:39]
    v_mfma_f32_16x16x32_bf16 v[52:55], v[96:99], v[68:71], v[52:55]
    v_mfma_f32_16x16x32_bf16 v[52:55], v[108:111], v[84:87], v[52:55]
    ds_read_b128 v[68:71], v2 offset:57344
    ds_read_b128 v[84:87], v2 offset:58368
    s_waitcnt vmcnt(10) lgkmcnt(6)
    v_mfma_f32_16x16x32_bf16 v[8:11], v[112:115], v[56:59], v[8:11]
    v_mfma_f32_16x16x32_bf16 v[8:11], v[124:127], v[72:75], v[8:11]
    s_waitcnt vmcnt(8)
    v_mfma_f32_16x16x32_bf16 v[24:27], v[116:119], v[56:59], v[24:27]
    v_mfma_f32_16x16x32_bf16 v[24:27], v[128:131], v[72:75], v[24:27]
    s_waitcnt vmcnt(6)
    v_mfma_f32_16x16x32_bf16 v[40:43], v[120:123], v[56:59], v[40:43]
    v_mfma_f32_16x16x32_bf16 v[40:43], v[132:135], v[72:75], v[40:43]
    ds_read_b128 v[56:59], v2 offset:4096
    ds_read_b128 v[72:75], v2 offset:5120
    s_waitcnt lgkmcnt(6)
    v_mfma_f32_16x16x32_bf16 v[12:15], v[112:115], v[60:63], v[12:15]
    v_mfma_f32_16x16x32_bf16 v[12:15], v[124:127], v[76:79], v[12:15]
    v_mfma_f32_16x16x32_bf16 v[28:31], v[116:119], v[60:63], v[28:31]
    v_mfma_f32_16x16x32_bf16 v[28:31], v[128:131], v[76:79], v[28:31]
    v_mfma_f32_16x16x32_bf16 v[44:47], v[120:123], v[60:63], v[44:47]
    v_mfma_f32_16x16x32_bf16 v[44:47], v[132:135], v[76:79], v[44:47]
    ds_read_b128 v[60:63], v2 offset:22528
    ds_read_b128 v[76:79], v2 offset:23552
    s_waitcnt lgkmcnt(6)
    v_mfma_f32_16x16x32_bf16 v[16:19], v[112:115], v[64:67], v[16:19]
    v_mfma_f32_16x16x32_bf16 v[16:19], v[124:127], v[80:83], v[16:19]
    v_mfma_f32_16x16x32_bf16 v[32:35], v[116:119], v[64:67], v[32:35]
    v_mfma_f32_16x16x32_bf16 v[32:35], v[128:131], v[80:83], v[32:35]
    v_mfma_f32_16x16x32_bf16 v[48:51], v[120:123], v[64:67], v[48:51]
    v_mfma_f32_16x16x32_bf16 v[48:51], v[132:135], v[80:83], v[48:51]
    ds_read_b128 v[64:67], v2 offset:40960
    ds_read_b128 v[80:83], v2 offset:41984
    s_waitcnt lgkmcnt(6)
    v_mfma_f32_16x16x32_bf16 v[20:23], v[112:115], v[68:71], v[20:23]
    v_mfma_f32_16x16x32_bf16 v[20:23], v[124:127], v[84:87], v[20:23]
    v_mfma_f32_16x16x32_bf16 v[36:39], v[116:119], v[68:71], v[36:39]
    v_mfma_f32_16x16x32_bf16 v[36:39], v[128:131], v[84:87], v[36:39]
    v_mfma_f32_16x16x32_bf16 v[52:55], v[120:123], v[68:71], v[52:55]
    v_mfma_f32_16x16x32_bf16 v[52:55], v[132:135], v[84:87], v[52:55]
    ds_read_b128 v[68:71], v2 offset:59392
    ds_read_b128 v[84:87], v2 offset:60416
    s_waitcnt vmcnt(4) lgkmcnt(6)
    v_mfma_f32_16x16x32_bf16 v[8:11], v[136:139], v[56:59], v[8:11]
    v_mfma_f32_16x16x32_bf16 v[8:11], v[148:151], v[72:75], v[8:11]
    s_waitcnt vmcnt(2)
    v_mfma_f32_16x16x32_bf16 v[24:27], v[140:143], v[56:59], v[24:27]
    v_mfma_f32_16x16x32_bf16 v[24:27], v[152:155], v[72:75], v[24:27]
    s_waitcnt vmcnt(0)
    v_mfma_f32_16x16x32_bf16 v[40:43], v[144:147], v[56:59], v[40:43]
    v_mfma_f32_16x16x32_bf16 v[40:43], v[156:159], v[72:75], v[40:43]
    s_waitcnt lgkmcnt(4)
    v_mfma_f32_16x16x32_bf16 v[12:15], v[136:139], v[60:63], v[12:15]
    v_mfma_f32_16x16x32_bf16 v[12:15], v[148:151], v[76:79], v[12:15]
    v_mfma_f32_16x16x32_bf16 v[28:31], v[140:143], v[60:63], v[28:31]
    v_mfma_f32_16x16x32_bf16 v[28:31], v[152:155], v[76:79], v[28:31]
    v_mfma_f32_16x16x32_bf16 v[44:47], v[144:147], v[60:63], v[44:47]
    v_mfma_f32_16x16x32_bf16 v[44:47], v[156:159], v[76:79], v[44:47]
    s_waitcnt lgkmcnt(2)
    v_mfma_f32_16x16x32_bf16 v[16:19], v[136:139], v[64:67], v[16:19]
    v_mfma_f32_16x16x32_bf16 v[16:19], v[148:151], v[80:83], v[16:19]
    v_mfma_f32_16x16x32_bf16 v[32:35], v[140:143], v[64:67], v[32:35]
    v_mfma_f32_16x16x32_bf16 v[32:35], v[152:155], v[80:83], v[32:35]
    v_mfma_f32_16x16x32_bf16 v[48:51], v[144:147], v[64:67], v[48:51]
    v_mfma_f32_16x16x32_bf16 v[48:51], v[156:159], v[80:83], v[48:51]
    s_waitcnt lgkmcnt(0)
    v_mfma_f32_16x16x32_bf16 v[20:23], v[136:139], v[68:71], v[20:23]
    v_mfma_f32_16x16x32_bf16 v[20:23], v[148:151], v[84:87], v[20:23]
    v_mfma_f32_16x16x32_bf16 v[36:39], v[140:143], v[68:71], v[36:39]
    v_mfma_f32_16x16x32_bf16 v[36:39], v[152:155], v[84:87], v[36:39]
    v_mfma_f32_16x16x32_bf16 v[52:55], v[144:147], v[68:71], v[52:55]
    v_mfma_f32_16x16x32_bf16 v[52:55], v[156:159], v[84:87], v[52:55]
km_kernel_efin:
    s_waitcnt lgkmcnt(0)
    s_mul_i32 s16, s12, 2359296
    s_add_u32 s16, s16, s24
    s_add_u32 s16, s16, s21
    s_add_u32 s30, s16, 33554432
    s_add_u32 s31, s30, 36864
    s_lshr_b32 s29, s14, 2
    s_lshl_b32 s26, s29, 8
    s_add_u32 s26, s26, s2
    s_lshl_b32 s26, s26, 7
    s_add_u32 s26, s26, 19365888
    s_lshl_b32 s27, s29, 2
    s_add_u32 s27, s27, 163424
    s_mov_b32 s16, 0xffff
    s_bitcmp1_b32 s12, 1
    s_cselect_b32 s16, 0xffff0000, s16
    s_lshr_b32 s17, s14, 1
    s_xor_b32 s17, s17, s12
    s_bitcmp0_b32 s17, 0
    s_cselect_b32 s16, s16, 0
    s_bitcmp0_b32 s12, 2
    s_cselect_b32 s36, s16, 0
    s_cselect_b32 s38, 0, s16
    s_mov_b32 s37, s36
    s_mov_b32 s39, s38
    s_not_b64 s[32:33], s[36:37]
    s_not_b64 s[34:35], s[38:39]
    s_and_b32 s16, s12, 4
    s_mul_i32 s16, s16, 9216
    s_add_u32 s16, s16, s21
    s_add_u32 s17, s16, 18432
    s_sub_u32 s16, s16, 18432
    s_bitcmp1_b32 s12, 1
    s_cselect_b32 s16, s16, s17
    v_add_u32 v5, s16, v4
    v_cvt_pk_bf16_f32 v8, v8, v9
    v_cvt_pk_bf16_f32 v9, v10, v11
    v_cvt_pk_bf16_f32 v10, v12, v13
    v_cvt_pk_bf16_f32 v11, v14, v15
    s_nop 1
    v_permlane16_swap_b32 v8, v10
    v_permlane16_swap_b32 v9, v11
    s_mov_b64 exec, s[32:33]
    buffer_store_dwordx4 v[8:11], v4, s[8:11], s30 offen offset:0 sc1
    s_mov_b64 exec, s[36:37]
    ds_write_b128 v5, v[8:11] offset:0
    s_mov_b64 exec, -1
    v_cvt_pk_bf16_f32 v16, v16, v17
    v_cvt_pk_bf16_f32 v17, v18, v19
    v_cvt_pk_bf16_f32 v18, v20, v21
    v_cvt_pk_bf16_f32 v19, v22, v23
    s_nop 1
    v_permlane16_swap_b32 v16, v18
    v_permlane16_swap_b32 v17, v19
    s_mov_b64 exec, s[34:35]
    buffer_store_dwordx4 v[16:19], v4, s[8:11], s31 offen offset:0 sc1
    s_mov_b64 exec, s[38:39]
    ds_write_b128 v5, v[16:19] offset:0
    s_mov_b64 exec, -1
    v_cvt_pk_bf16_f32 v24, v24, v25
    v_cvt_pk_bf16_f32 v25, v26, v27
    v_cvt_pk_bf16_f32 v26, v28, v29
    v_cvt_pk_bf16_f32 v27, v30, v31
    s_nop 1
    v_permlane16_swap_b32 v24, v26
    v_permlane16_swap_b32 v25, v27
    s_mov_b64 exec, s[32:33]
    buffer_store_dwordx4 v[24:27], v4, s[8:11], s30 offen offset:512 sc1
    s_mov_b64 exec, s[36:37]
    ds_write_b128 v5, v[24:27] offset:512
    s_mov_b64 exec, -1
    v_cvt_pk_bf16_f32 v32, v32, v33
    v_cvt_pk_bf16_f32 v33, v34, v35
    v_cvt_pk_bf16_f32 v34, v36, v37
    v_cvt_pk_bf16_f32 v35, v38, v39
    s_nop 1
    v_permlane16_swap_b32 v32, v34
    v_permlane16_swap_b32 v33, v35
    s_mov_b64 exec, s[34:35]
    buffer_store_dwordx4 v[32:35], v4, s[8:11], s31 offen offset:512 sc1
    s_mov_b64 exec, s[38:39]
    ds_write_b128 v5, v[32:35] offset:512
    s_mov_b64 exec, -1
    v_cvt_pk_bf16_f32 v40, v40, v41
    v_cvt_pk_bf16_f32 v41, v42, v43
    v_cvt_pk_bf16_f32 v42, v44, v45
    v_cvt_pk_bf16_f32 v43, v46, v47
    s_nop 1
    v_permlane16_swap_b32 v40, v42
    v_permlane16_swap_b32 v41, v43
    s_mov_b64 exec, s[32:33]
    buffer_store_dwordx4 v[40:43], v4, s[8:11], s30 offen offset:1024 sc1
    s_mov_b64 exec, s[36:37]
    ds_write_b128 v5, v[40:43] offset:1024
    s_mov_b64 exec, -1
    v_cvt_pk_bf16_f32 v48, v48, v49
    v_cvt_pk_bf16_f32 v49, v50, v51
    v_cvt_pk_bf16_f32 v50, v52, v53
    v_cvt_pk_bf16_f32 v51, v54, v55
    s_nop 1
    v_permlane16_swap_b32 v48, v50
    v_permlane16_swap_b32 v49, v51
    s_mov_b64 exec, s[34:35]
    buffer_store_dwordx4 v[48:51], v4, s[8:11], s31 offen offset:1024 sc1
    s_mov_b64 exec, s[38:39]
    ds_write_b128 v5, v[48:51] offset:1024
    s_mov_b64 exec, -1
    v_mov_b32 v160, 163440
    v_mov_b32 v161, 1
    s_mov_b64 exec, 1
    ds_add_u32 v160, v161
    s_mov_b64 exec, -1
    s_waitcnt vmcnt(0)
    v_mov_b32 v160, s27
    v_mov_b32 v161, 1
    s_mov_b64 exec, 1
    ds_add_rtn_u32 v161, v160, v161
    s_waitcnt lgkmcnt(0)
    v_readfirstlane_b32 s16, v161
    v_mov_b32 v160, s15
    s_cmp_lg_u32 s16, 3
    s_cbranch_scc1 sig_109
    buffer_store_dword v160, off, s[8:11], s26 sc1
sig_109:
    s_mov_b64 exec, -1
    s_and_b32 s22, s14, 3
    s_cmp_eq_u32 s22, 3
    s_cbranch_scc1 km_kernel_end
    s_load_dwordx2 s[6:7], s[0:1], 112
    s_mul_i32 s21, s29, 6
    s_add_u32 s21, s21, s22
    s_and_b32 s22, s12, 1
    s_mul_i32 s22, s22, 3
    s_add_u32 s21, s21, s22
    s_lshr_b32 s22, s2, 1
    s_mul_i32 s22, s22, 18432
    s_lshl_b32 s20, s21, 10
    s_add_u32 s20, s20, s22
    s_lshl_b32 s21, s21, 6
    s_add_u32 s21, s21, s22
    s_add_u32 s22, s20, 7077888
    s_sub_u32 s23, s20, s24
    v_add_u32 v6, s23, v1
    ds_read_b128 v[40:43], v6
    buffer_load_dwordx4 v[44:47], v1, s[8:11], s22 offen sc1
    v_min_u32 v5, 6, v3
    v_add_u32 v5, 1, v5
    v_xor_b32 v5, s12, v5
    s_lshl_b32 s16, s13, 3
    s_lshl_b32 s17, s29, 8
    s_add_u32 s16, s16, s17
    v_add_lshl_u32 v5, v5, s16, 7
    s_add_u32 s16, s23, 18432
    s_sub_u32 s17, s23, 18432
    s_bitcmp1_b32 s12, 1
    s_cselect_b32 s16, s17, s16
    v_add_u32 v7, s16, v1
    v_and_b32 v2, 15, v3
    v_mul_u32_u24 v2, 1152, v2
    v_and_b32 v4, 48, v3
    v_add_u32 v2, v2, v4
    s_waitcnt lgkmcnt(0)
    s_mov_b32 s28, s6
    s_and_b32 s29, s7, 0xffff
    s_mov_b32 s30, 0x240000
    s_mov_b32 s31, 0x20000
    v_mov_b32 v160, 163440
    s_mov_b32 s17, 262144
lw_110:
    ds_read_b32 v161, v160
    s_sub_u32 s17, s17, 1
    s_waitcnt lgkmcnt(0)
    v_readfirstlane_b32 s16, v161
    s_cmp_eq_u32 s17, 0
    s_cbranch_scc1 lwd_111
    s_cmp_ge_u32 s16, 12
    s_cbranch_scc1 lwd_111
    s_sleep 8
    s_branch lw_110
lwd_111:
    s_mov_b32 s16, 19365888
    s_mov_b32 s17, 32768
poll_112:
    buffer_load_dword v60, v5, s[8:11], s16 offen sc1
    s_sub_u32 s17, s17, 1
    s_cmp_eq_u32 s17, 0
    s_waitcnt vmcnt(0)
    s_cbranch_scc1 pdone_113
    v_xor_b32 v60, s15, v60
    v_cmp_ne_u32 vcc, 0, v60
    s_nop 4
    s_cbranch_vccz pdone_113
    s_sleep 1
    s_branch poll_112
pdone_113:
    s_add_u32 s17, s20, 33554432
    s_cmp_eq_u32 s12, 0
    s_cbranch_scc1 own_114
    buffer_load_dwordx4 v[8:11], v1, s[8:11], s17 offen sc1
    s_branch ownj_115
own_114:
    ds_read_b128 v[8:11], v7
ownj_115:
    s_add_u32 s17, s17, 2359296
    s_cmp_eq_u32 s12, 1
    s_cbranch_scc1 own_116
    buffer_load_dwordx4 v[12:15], v1, s[8:11], s17 offen sc1
    s_branch ownj_117
own_116:
    ds_read_b128 v[12:15], v7
ownj_117:
    s_add_u32 s17, s17, 2359296
    s_cmp_eq_u32 s12, 2
    s_cbranch_scc1 own_118
    buffer_load_dwordx4 v[16:19], v1, s[8:11], s17 offen sc1
    s_branch ownj_119
own_118:
    ds_read_b128 v[16:19], v7
ownj_119:
    s_add_u32 s17, s17, 2359296
    s_cmp_eq_u32 s12, 3
    s_cbranch_scc1 own_120
    buffer_load_dwordx4 v[20:23], v1, s[8:11], s17 offen sc1
    s_branch ownj_121
own_120:
    ds_read_b128 v[20:23], v7
ownj_121:
    s_add_u32 s17, s17, 2359296
    s_cmp_eq_u32 s12, 4
    s_cbranch_scc1 own_122
    buffer_load_dwordx4 v[24:27], v1, s[8:11], s17 offen sc1
    s_branch ownj_123
own_122:
    ds_read_b128 v[24:27], v7
ownj_123:
    s_add_u32 s17, s17, 2359296
    s_cmp_eq_u32 s12, 5
    s_cbranch_scc1 own_124
    buffer_load_dwordx4 v[28:31], v1, s[8:11], s17 offen sc1
    s_branch ownj_125
own_124:
    ds_read_b128 v[28:31], v7
ownj_125:
    s_add_u32 s17, s17, 2359296
    s_cmp_eq_u32 s12, 6
    s_cbranch_scc1 own_126
    buffer_load_dwordx4 v[32:35], v1, s[8:11], s17 offen sc1
    s_branch ownj_127
own_126:
    ds_read_b128 v[32:35], v7
ownj_127:
    s_add_u32 s17, s17, 2359296
    s_cmp_eq_u32 s12, 7
    s_cbranch_scc1 own_128
    buffer_load_dwordx4 v[36:39], v1, s[8:11], s17 offen sc1
    s_branch ownj_129
own_128:
    ds_read_b128 v[36:39], v7
ownj_129:
    s_waitcnt vmcnt(6) lgkmcnt(0)
    v_lshlrev_b32 v48, 16, v8
    v_and_b32 v49, 0xffff0000, v8
    v_lshlrev_b32 v50, 16, v9
    v_and_b32 v51, 0xffff0000, v9
    v_lshlrev_b32 v52, 16, v10
    v_and_b32 v53, 0xffff0000, v10
    v_lshlrev_b32 v54, 16, v11
    v_and_b32 v55, 0xffff0000, v11
    s_waitcnt vmcnt(5)
    v_lshlrev_b32 v4, 16, v12
    v_and_b32 v5, 0xffff0000, v12
    v_add_f32 v48, v48, v4
    v_add_f32 v49, v49, v5
    v_lshlrev_b32 v4, 16, v13
    v_and_b32 v5, 0xffff0000, v13
    v_add_f32 v50, v50, v4
    v_add_f32 v51, v51, v5
    v_lshlrev_b32 v4, 16, v14
    v_and_b32 v5, 0xffff0000, v14
    v_add_f32 v52, v52, v4
    v_add_f32 v53, v53, v5
    v_lshlrev_b32 v4, 16, v15
    v_and_b32 v5, 0xffff0000, v15
    v_add_f32 v54, v54, v4
    v_add_f32 v55, v55, v5
    s_waitcnt vmcnt(4)
    v_lshlrev_b32 v4, 16, v16
    v_and_b32 v5, 0xffff0000, v16
    v_add_f32 v48, v48, v4
    v_add_f32 v49, v49, v5
    v_lshlrev_b32 v4, 16, v17
    v_and_b32 v5, 0xffff0000, v17
    v_add_f32 v50, v50, v4
    v_add_f32 v51, v51, v5
    v_lshlrev_b32 v4, 16, v18
    v_and_b32 v5, 0xffff0000, v18
    v_add_f32 v52, v52, v4
    v_add_f32 v53, v53, v5
    v_lshlrev_b32 v4, 16, v19
    v_and_b32 v5, 0xffff0000, v19
    v_add_f32 v54, v54, v4
    v_add_f32 v55, v55, v5
    s_waitcnt vmcnt(3)
    v_lshlrev_b32 v4, 16, v20
    v_and_b32 v5, 0xffff0000, v20
    v_add_f32 v48, v48, v4
    v_add_f32 v49, v49, v5
    v_lshlrev_b32 v4, 16, v21
    v_and_b32 v5, 0xffff0000, v21
    v_add_f32 v50, v50, v4
    v_add_f32 v51, v51, v5
    v_lshlrev_b32 v4, 16, v22
    v_and_b32 v5, 0xffff0000, v22
    v_add_f32 v52, v52, v4
    v_add_f32 v53, v53, v5
    v_lshlrev_b32 v4, 16, v23
    v_and_b32 v5, 0xffff0000, v23
    v_add_f32 v54, v54, v4
    v_add_f32 v55, v55, v5
    s_waitcnt vmcnt(2)
    v_lshlrev_b32 v4, 16, v24
    v_and_b32 v5, 0xffff0000, v24
    v_add_f32 v48, v48, v4
    v_add_f32 v49, v49, v5
    v_lshlrev_b32 v4, 16, v25
    v_and_b32 v5, 0xffff0000, v25
    v_add_f32 v50, v50, v4
    v_add_f32 v51, v51, v5
    v_lshlrev_b32 v4, 16, v26
    v_and_b32 v5, 0xffff0000, v26
    v_add_f32 v52, v52, v4
    v_add_f32 v53, v53, v5
    v_lshlrev_b32 v4, 16, v27
    v_and_b32 v5, 0xffff0000, v27
    v_add_f32 v54, v54, v4
    v_add_f32 v55, v55, v5
    s_waitcnt vmcnt(1)
    v_lshlrev_b32 v4, 16, v28
    v_and_b32 v5, 0xffff0000, v28
    v_add_f32 v48, v48, v4
    v_add_f32 v49, v49, v5
    v_lshlrev_b32 v4, 16, v29
    v_and_b32 v5, 0xffff0000, v29
    v_add_f32 v50, v50, v4
    v_add_f32 v51, v51, v5
    v_lshlrev_b32 v4, 16, v30
    v_and_b32 v5, 0xffff0000, v30
    v_add_f32 v52, v52, v4
    v_add_f32 v53, v53, v5
    v_lshlrev_b32 v4, 16, v31
    v_and_b32 v5, 0xffff0000, v31
    v_add_f32 v54, v54, v4
    v_add_f32 v55, v55, v5
    s_waitcnt vmcnt(0)
    v_lshlrev_b32 v4, 16, v32
    v_and_b32 v5, 0xffff0000, v32
    v_add_f32 v48, v48, v4
    v_add_f32 v49, v49, v5
    v_lshlrev_b32 v4, 16, v33
    v_and_b32 v5, 0xffff0000, v33
    v_add_f32 v50, v50, v4
    v_add_f32 v51, v51, v5
    v_lshlrev_b32 v4, 16, v34
    v_and_b32 v5, 0xffff0000, v34
    v_add_f32 v52, v52, v4
    v_add_f32 v53, v53, v5
    v_lshlrev_b32 v4, 16, v35
    v_and_b32 v5, 0xffff0000, v35
    v_add_f32 v54, v54, v4
    v_add_f32 v55, v55, v5
    s_waitcnt vmcnt(0)
    v_lshlrev_b32 v4, 16, v36
    v_and_b32 v5, 0xffff0000, v36
    v_add_f32 v48, v48, v4
    v_add_f32 v49, v49, v5
    v_lshlrev_b32 v4, 16, v37
    v_and_b32 v5, 0xffff0000, v37
    v_add_f32 v50, v50, v4
    v_add_f32 v51, v51, v5
    v_lshlrev_b32 v4, 16, v38
    v_and_b32 v5, 0xffff0000, v38
    v_add_f32 v52, v52, v4
    v_add_f32 v53, v53, v5
    v_lshlrev_b32 v4, 16, v39
    v_and_b32 v5, 0xffff0000, v39
    v_add_f32 v54, v54, v4
    v_add_f32 v55, v55, v5
    v_cvt_pk_bf16_f32 v6, v48, v49
    v_lshlrev_b32 v4, 16, v40
    v_and_b32 v5, 0xffff0000, v40
    v_lshlrev_b32 v48, 16, v6
    v_and_b32 v49, 0xffff0000, v6
    v_add_f32 v48, v48, v4
    v_add_f32 v49, v49, v5
    v_cvt_pk_bf16_f32 v6, v50, v51
    v_lshlrev_b32 v4, 16, v41
    v_and_b32 v5, 0xffff0000, v41
    v_lshlrev_b32 v50, 16, v6
    v_and_b32 v51, 0xffff0000, v6
    v_add_f32 v50, v50, v4
    v_add_f32 v51, v51, v5
    v_cvt_pk_bf16_f32 v6, v52, v53
    v_lshlrev_b32 v4, 16, v42
    v_and_b32 v5, 0xffff0000, v42
    v_lshlrev_b32 v52, 16, v6
    v_and_b32 v53, 0xffff0000, v6
    v_add_f32 v52, v52, v4
    v_add_f32 v53, v53, v5
    v_cvt_pk_bf16_f32 v6, v54, v55
    v_lshlrev_b32 v4, 16, v43
    v_and_b32 v5, 0xffff0000, v43
    v_lshlrev_b32 v54, 16, v6
    v_and_b32 v55, 0xffff0000, v6
    v_add_f32 v54, v54, v4
    v_add_f32 v55, v55, v5
    v_cvt_pk_bf16_f32 v6, v48, v49
    v_lshlrev_b32 v4, 16, v44
    v_and_b32 v5, 0xffff0000, v44
    v_lshlrev_b32 v48, 16, v6
    v_and_b32 v49, 0xffff0000, v6
    v_add_f32 v48, v48, v4
    v_add_f32 v49, v49, v5
    v_cvt_pk_bf16_f32 v6, v50, v51
    v_lshlrev_b32 v4, 16, v45
    v_and_b32 v5, 0xffff0000, v45
    v_lshlrev_b32 v50, 16, v6
    v_and_b32 v51, 0xffff0000, v6
    v_add_f32 v50, v50, v4
    v_add_f32 v51, v51, v5
    v_cvt_pk_bf16_f32 v6, v52, v53
    v_lshlrev_b32 v4, 16, v46
    v_and_b32 v5, 0xffff0000, v46
    v_lshlrev_b32 v52, 16, v6
    v_and_b32 v53, 0xffff0000, v6
    v_add_f32 v52, v52, v4
    v_add_f32 v53, v53, v5
    v_cvt_pk_bf16_f32 v6, v54, v55
    v_lshlrev_b32 v4, 16, v47
    v_and_b32 v5, 0xffff0000, v47
    v_lshlrev_b32 v54, 16, v6
    v_and_b32 v55, 0xffff0000, v6
    v_add_f32 v54, v54, v4
    v_add_f32 v55, v55, v5
    v_cvt_pk_bf16_f32 v8, v48, v49
    v_cvt_pk_bf16_f32 v9, v50, v51
    v_cvt_pk_bf16_f32 v10, v52, v53
    v_cvt_pk_bf16_f32 v11, v54, v55
    buffer_store_dwordx4 v[8:11], v2, s[28:31], s21 offen
    s_branch km_kernel_end
km_kernel_end:
    s_endpgm
.section .rodata,"a"
.p2align 6
.amdhsa_kernel km_kernel
  .amdhsa_next_free_vgpr 168
  .amdhsa_next_free_sgpr 102
  .amdhsa_accum_offset 168
  .amdhsa_group_segment_fixed_size 0
  .amdhsa_kernarg_size 136
  .amdhsa_user_sgpr_count 2
  .amdhsa_user_sgpr_kernarg_segment_ptr 1
  .amdhsa_system_sgpr_workgroup_id_x 1
.end_amdhsa_kernel
```
